```python
import torch

def _softmax(x, axis=-1):
    return torch.softmax(x, dim=axis)
def _gelu(x):
    return torch.nn.functional.gelu(x, approximate="tanh")
def _silu(x):
    return torch.nn.functional.silu(x)
def _sigmoid(x):
    return torch.sigmoid(x)
def _layernorm(x, axis=-1, eps=1e-5):
    m = x.mean(dim=axis, keepdim=True)
    v = x.var(dim=axis, keepdim=True, unbiased=False)
    return (x - m) / torch.sqrt(v + eps)
def _scatter_add(tgt, idx, src, axis=0):
    return tgt.clone().index_add_(axis, idx, src)
def _segment_sum(src, seg, n):
    out = torch.zeros((n,) + src.shape[1:], dtype=src.dtype)
    return out.index_add_(0, seg, src)
def _pad(x, pw):
    flat = tuple(v for pair in reversed(pw) for v in pair)
    return torch.nn.functional.pad(x, flat)

kernel_name = 'standalone__molecular_angular_gemnet__graph'

def setup_inputs():

    _w = (lambda a: (lambda t: t.to(torch.bfloat16) if t.is_floating_point() else t)(torch.as_tensor(a)))
    N, deg, De, L = 25000, 16, 16, 1
    E = N * deg
    T = E * deg
    NR = 8
    dist = torch.rand(E).to(float)
    angle = (torch.rand(T) * torch.pi).to(float)
    centers = torch.linspace(0.0, 1.0, NR).to(float)
    ang_freq = torch.arange(1, L + 1).to(float)
    return {
        "m": _w((lambda *s: torch.randn(*s, dtype=torch.bfloat16) * 0.05)(E, De)),
        "idx_in": _w((lambda lo, hi, *s: torch.randint(lo, hi, s))(0, E, T).to(torch.int64)),
        "idx_out": _w((lambda lo, hi, *s: torch.randint(lo, hi, s))(0, E, T).to(torch.int64)),
        "dist": _w(dist),
        "angle": _w(angle),
        "centers": _w(centers),
        "ang_freq": _w(ang_freq),
        "w_rbf": _w((lambda *s: torch.randn(*s, dtype=torch.bfloat16) * 0.2)(NR, De)),
        "w_sbf": _w((lambda *s: torch.randn(*s, dtype=torch.bfloat16) * 0.2)(NR * L, De)),
        "w_down": _w((lambda *s: torch.randn(*s, dtype=torch.bfloat16) * 0.2)(De, De)),
        "w_up": _w((lambda *s: torch.randn(*s, dtype=torch.bfloat16) * 0.2)(De, De)),
    }

def reference(m, idx_in, idx_out, dist, angle, centers, ang_freq, w_rbf, w_sbf, w_down, w_up):
    E, De = m.shape[0], m.shape[1]
    NR = centers.shape[0]
    L = ang_freq.shape[0]
    rbf = torch.exp(-10.0 * (dist[:, None] - centers[None, :]) ** 2)
    cbf = torch.cos(ang_freq[None, :] * angle[:, None])
    rbf_t = rbf[idx_out]
    sbf = torch.reshape(rbf_t[:, :, None] * cbf[:, None, :], (-1, NR * L))
    x = (m[idx_in] @ w_down) * (sbf @ w_sbf)
    agg = _segment_sum(x, idx_out, E)
    return m + (agg @ w_up) * (rbf @ w_rbf)
```

```asm
; @launch kernel=standalone__molecular_angular_gemnet__graph_part_kernel grid=(256,1,1) block=(1024,1,1) lds=162560
; @launch kernel=standalone__molecular_angular_gemnet__graph_kernel grid=(256,1,1) block=(1024,1,1) lds=131072
.amdgcn_target "amdgcn-amd-amdhsa--gfx950"
.text
.globl standalone__molecular_angular_gemnet__graph_part_kernel
.p2align 8
.type standalone__molecular_angular_gemnet__graph_part_kernel,@function
standalone__molecular_angular_gemnet__graph_part_kernel:
  s_cmp_ge_u32 s2, 256
  s_cbranch_scc1 LA_end
  s_load_dwordx4 s[4:7], s[0:1], 0
  s_load_dwordx2 s[8:9], s[0:1], 16
  s_load_dwordx2 s[10:11], s[0:1], 32
  s_load_dwordx2 s[12:13], s[0:1], 48
  s_load_dwordx2 s[14:15], s[0:1], 104
  v_lshrrev_b32 v1, 6, v0
  v_lshlrev_b32 v4, 4, v0
  v_readfirstlane_b32 s50, v1
  v_lshlrev_b32 v5, 3, v0
  v_lshlrev_b32 v6, 2, v0
  v_lshlrev_b32 v7, 1, v0
  v_mov_b32 v2, 2
  v_mov_b32 v116, 0
  v_mov_b32 v117, 0
  s_mul_i32 s46, s2, 390
  s_min_u32 s47, s2, 160
  s_add_u32 s46, s46, s47
  s_lshl_b32 s48, s46, 8
  s_lshl_b32 s49, s46, 7
  s_mov_b32 s59, 24960
  s_cmp_lt_u32 s2, 160
  s_cselect_b32 s59, 25024, s59
  s_mul_i32 s64, s2, 100096
  s_mul_i32 s65, s2, 50048
  s_lshl_b32 s51, s2, 10
  s_lshl_b32 s52, s2, 3
  s_waitcnt lgkmcnt(0)
  s_add_u32 s16, s6, s48
  s_addc_u32 s17, s7, 0
  s_and_b32 s17, s17, 0xffff
  s_mov_b32 s18, 100096
  s_mov_b32 s19, 0x20000
  s_add_u32 s20, s8, s48
  s_addc_u32 s21, s9, 0
  s_and_b32 s21, s21, 0xffff
  s_mov_b32 s22, 100096
  s_mov_b32 s23, 0x20000
  s_add_u32 s24, s10, s49
  s_addc_u32 s25, s11, 0
  s_and_b32 s25, s25, 0xffff
  s_mov_b32 s26, 50048
  s_mov_b32 s27, 0x20000
  s_lshl_b32 s18, s59, 2
  s_lshl_b32 s22, s59, 2
  s_lshl_b32 s26, s59, 1
  v_mul_u32_u24 v126, 12, v0
  ds_write_b32 v126, v116 offset:0
  ds_write_b32 v126, v116 offset:4
  ds_write_b32 v126, v116 offset:8
  v_and_b32 v118, 15, v0
  v_lshlrev_b32 v118, 3, v118
  v_add_u32 v118, 162432, v118
  ds_write_b64 v118, v[116:117]
  global_load_ushort v3, v116, s[12:13]
  s_setprio 3
  s_mov_b32 s53, 0
  s_mov_b32 s54, 0
  buffer_load_dwordx4 v[8:11], v4, s[16:19], s53 offen nt
  buffer_load_dwordx4 v[34:37], v4, s[20:23], s53 offen nt
  buffer_load_dwordx2 v[60:61], v5, s[24:27], s54 offen nt
  s_mov_b32 s53, 16384
  s_mov_b32 s54, 8192
  buffer_load_dwordx4 v[12:15], v4, s[16:19], s53 offen nt
  buffer_load_dwordx4 v[38:41], v4, s[20:23], s53 offen nt
  buffer_load_dwordx2 v[62:63], v5, s[24:27], s54 offen nt
  s_waitcnt lgkmcnt(0)
  s_barrier
  s_mov_b32 s53, 32768
  s_mov_b32 s54, 16384
  buffer_load_dwordx4 v[16:19], v4, s[16:19], s53 offen nt
  buffer_load_dwordx4 v[42:45], v4, s[20:23], s53 offen nt
  buffer_load_dwordx2 v[64:65], v5, s[24:27], s54 offen nt
  s_mov_b32 s53, 49152
  s_mov_b32 s54, 24576
  buffer_load_dwordx4 v[20:23], v4, s[16:19], s53 offen nt
  buffer_load_dwordx4 v[46:49], v4, s[20:23], s53 offen nt
  buffer_load_dwordx2 v[66:67], v5, s[24:27], s54 offen nt
  s_mov_b32 s53, 65536
  s_mov_b32 s54, 32768
  buffer_load_dwordx4 v[24:27], v4, s[16:19], s53 offen nt
  buffer_load_dwordx4 v[50:53], v4, s[20:23], s53 offen nt
  buffer_load_dwordx2 v[68:69], v5, s[24:27], s54 offen nt
  s_mov_b32 s53, 81920
  s_mov_b32 s54, 40960
  buffer_load_dwordx4 v[28:31], v4, s[16:19], s53 offen nt
  buffer_load_dwordx4 v[54:57], v4, s[20:23], s53 offen nt
  buffer_load_dwordx2 v[70:71], v5, s[24:27], s54 offen nt
  s_mov_b32 s53, 98304
  s_mov_b32 s54, 49152
  buffer_load_dword v32, v6, s[16:19], s53 offen nt
  buffer_load_dword v58, v6, s[20:23], s53 offen nt
  buffer_load_ushort v72, v7, s[24:27], s54 offen nt
  s_setprio 0
  s_mul_i32 s47, s2, 50048
  s_add_u32 s28, s4, s47
  s_addc_u32 s29, s5, 0
  s_and_b32 s29, s29, 0xffff
  s_mov_b32 s30, 50048
  s_mov_b32 s31, 0x20000
  s_sub_u32 s47, 12800000, s47
  s_min_u32 s30, s47, 50048
  s_add_u32 s32, s14, s64
  s_addc_u32 s33, s15, 0
  s_add_u32 s32, s32, 256
  s_addc_u32 s33, s33, 0
  s_and_b32 s33, s33, 0xffff
  s_mov_b32 s34, 100096
  s_mov_b32 s35, 0x20000
  s_add_u32 s36, s14, s65
  s_addc_u32 s37, s15, 0
  s_add_u32 s36, s36, 25624832
  s_addc_u32 s37, s37, 0
  s_and_b32 s37, s37, 0xffff
  s_mov_b32 s38, 50048
  s_mov_b32 s39, 0x20000
  s_lshl_b32 s34, s59, 2
  s_lshl_b32 s38, s59, 1
  s_sub_u32 s59, s59, 24576
  s_add_u32 s40, s14, s51
  s_addc_u32 s41, s15, 0
  s_add_u32 s40, s40, 38437120
  s_addc_u32 s41, s41, 0
  s_and_b32 s41, s41, 0xffff
  s_mov_b32 s42, 1024
  s_mov_b32 s43, 0x20000
  s_add_u32 s44, s14, s52
  s_addc_u32 s45, s15, 0
  s_add_u32 s44, s44, 38699264
  s_addc_u32 s45, s45, 0
  s_and_b32 s45, s45, 0xffff
  s_mov_b32 s46, 8
  s_mov_b32 s47, 0x20000
  s_mov_b32 s55, 2746143
  s_mov_b32 s56, 128848
  s_mov_b32 s57, -1564
  v_mov_b32 v124, 0
  s_waitcnt vmcnt(18)
  v_lshlrev_b32 v3, 16, v3
  v_mul_hi_u32_u24 v116, s55, v34
  v_mul_hi_u32_u24 v117, s56, v8
  v_mad_i32_i24 v118, v116, s57, v34
  v_lshlrev_b32 v117, 2, v117
  v_mad_u32_u24 v34, v116, 48, v117
  v_lshl_or_b32 v8, v118, 19, v8
  ds_add_rtn_u32 v74, v34, v2 offset:0
  v_not_b32 v8, v8
  v_mul_hi_u32_u24 v116, s55, v35
  v_mul_hi_u32_u24 v117, s56, v9
  v_mad_i32_i24 v118, v116, s57, v35
  v_lshlrev_b32 v117, 2, v117
  v_mad_u32_u24 v35, v116, 48, v117
  v_lshl_or_b32 v9, v118, 19, v9
  ds_add_rtn_u32 v75, v35, v2 offset:0
  v_not_b32 v9, v9
  v_mul_hi_u32_u24 v116, s55, v36
  v_mul_hi_u32_u24 v117, s56, v10
  v_mad_i32_i24 v118, v116, s57, v36
  v_lshlrev_b32 v117, 2, v117
  v_mad_u32_u24 v36, v116, 48, v117
  v_lshl_or_b32 v10, v118, 19, v10
  ds_add_rtn_u32 v76, v36, v2 offset:0
  v_not_b32 v10, v10
  v_mul_hi_u32_u24 v116, s55, v37
  v_mul_hi_u32_u24 v117, s56, v11
  v_mad_i32_i24 v118, v116, s57, v37
  v_lshlrev_b32 v117, 2, v117
  v_mad_u32_u24 v37, v116, 48, v117
  v_lshl_or_b32 v11, v118, 19, v11
  ds_add_rtn_u32 v77, v37, v2 offset:0
  v_not_b32 v11, v11
  v_lshlrev_b32 v119, 16, v60
  v_and_b32 v120, 0xffff0000, v60
  v_mul_f32 v119, v3, v119
  v_mul_f32 v120, v3, v120
  v_cvt_pk_bf16_f32 v121, v119, v120
  v_lshlrev_b32 v119, 16, v121
  v_and_b32 v120, 0xffff0000, v121
  v_mul_f32 v119, 0.15915494, v119
  v_mul_f32 v120, 0.15915494, v120
  v_fract_f32 v119, v119
  v_fract_f32 v120, v120
  v_cos_f32 v119, v119
  v_cos_f32 v120, v120
  s_nop 0
  v_cvt_pk_bf16_f32 v60, v119, v120
  v_and_b32 v119, 0x7fff7fff, v60
  v_pk_max_u16 v124, v124, v119
  v_lshlrev_b32 v119, 16, v61
  v_and_b32 v120, 0xffff0000, v61
  v_mul_f32 v119, v3, v119
  v_mul_f32 v120, v3, v120
  v_cvt_pk_bf16_f32 v121, v119, v120
  v_lshlrev_b32 v119, 16, v121
  v_and_b32 v120, 0xffff0000, v121
  v_mul_f32 v119, 0.15915494, v119
  v_mul_f32 v120, 0.15915494, v120
  v_fract_f32 v119, v119
  v_fract_f32 v120, v120
  v_cos_f32 v119, v119
  v_cos_f32 v120, v120
  s_nop 0
  v_cvt_pk_bf16_f32 v61, v119, v120
  v_and_b32 v119, 0x7fff7fff, v61
  v_pk_max_u16 v124, v124, v119
  s_waitcnt vmcnt(15)
  v_mul_hi_u32_u24 v116, s55, v38
  v_mul_hi_u32_u24 v117, s56, v12
  v_mad_i32_i24 v118, v116, s57, v38
  v_lshlrev_b32 v117, 2, v117
  v_mad_u32_u24 v38, v116, 48, v117
  v_lshl_or_b32 v12, v118, 19, v12
  ds_add_rtn_u32 v78, v38, v2 offset:0
  v_not_b32 v12, v12
  v_mul_hi_u32_u24 v116, s55, v39
  v_mul_hi_u32_u24 v117, s56, v13
  v_mad_i32_i24 v118, v116, s57, v39
  v_lshlrev_b32 v117, 2, v117
  v_mad_u32_u24 v39, v116, 48, v117
  v_lshl_or_b32 v13, v118, 19, v13
  ds_add_rtn_u32 v79, v39, v2 offset:0
  v_not_b32 v13, v13
  v_mul_hi_u32_u24 v116, s55, v40
  v_mul_hi_u32_u24 v117, s56, v14
  v_mad_i32_i24 v118, v116, s57, v40
  v_lshlrev_b32 v117, 2, v117
  v_mad_u32_u24 v40, v116, 48, v117
  v_lshl_or_b32 v14, v118, 19, v14
  ds_add_rtn_u32 v80, v40, v2 offset:0
  v_not_b32 v14, v14
  v_mul_hi_u32_u24 v116, s55, v41
  v_mul_hi_u32_u24 v117, s56, v15
  v_mad_i32_i24 v118, v116, s57, v41
  v_lshlrev_b32 v117, 2, v117
  v_mad_u32_u24 v41, v116, 48, v117
  v_lshl_or_b32 v15, v118, 19, v15
  ds_add_rtn_u32 v81, v41, v2 offset:0
  v_not_b32 v15, v15
  v_lshlrev_b32 v119, 16, v62
  v_and_b32 v120, 0xffff0000, v62
  v_mul_f32 v119, v3, v119
  v_mul_f32 v120, v3, v120
  v_cvt_pk_bf16_f32 v121, v119, v120
  v_lshlrev_b32 v119, 16, v121
  v_and_b32 v120, 0xffff0000, v121
  v_mul_f32 v119, 0.15915494, v119
  v_mul_f32 v120, 0.15915494, v120
  v_fract_f32 v119, v119
  v_fract_f32 v120, v120
  v_cos_f32 v119, v119
  v_cos_f32 v120, v120
  s_nop 0
  v_cvt_pk_bf16_f32 v62, v119, v120
  v_and_b32 v119, 0x7fff7fff, v62
  v_pk_max_u16 v124, v124, v119
  v_lshlrev_b32 v119, 16, v63
  v_and_b32 v120, 0xffff0000, v63
  v_mul_f32 v119, v3, v119
  v_mul_f32 v120, v3, v120
  v_cvt_pk_bf16_f32 v121, v119, v120
  v_lshlrev_b32 v119, 16, v121
  v_and_b32 v120, 0xffff0000, v121
  v_mul_f32 v119, 0.15915494, v119
  v_mul_f32 v120, 0.15915494, v120
  v_fract_f32 v119, v119
  v_fract_f32 v120, v120
  v_cos_f32 v119, v119
  v_cos_f32 v120, v120
  s_nop 0
  v_cvt_pk_bf16_f32 v63, v119, v120
  v_and_b32 v119, 0x7fff7fff, v63
  v_pk_max_u16 v124, v124, v119
  s_waitcnt vmcnt(12)
  v_mul_hi_u32_u24 v116, s55, v42
  v_mul_hi_u32_u24 v117, s56, v16
  v_mad_i32_i24 v118, v116, s57, v42
  v_lshlrev_b32 v117, 2, v117
  v_mad_u32_u24 v42, v116, 48, v117
  v_lshl_or_b32 v16, v118, 19, v16
  ds_add_rtn_u32 v82, v42, v2 offset:0
  v_not_b32 v16, v16
  v_mul_hi_u32_u24 v116, s55, v43
  v_mul_hi_u32_u24 v117, s56, v17
  v_mad_i32_i24 v118, v116, s57, v43
  v_lshlrev_b32 v117, 2, v117
  v_mad_u32_u24 v43, v116, 48, v117
  v_lshl_or_b32 v17, v118, 19, v17
  ds_add_rtn_u32 v83, v43, v2 offset:0
  v_not_b32 v17, v17
  v_mul_hi_u32_u24 v116, s55, v44
  v_mul_hi_u32_u24 v117, s56, v18
  v_mad_i32_i24 v118, v116, s57, v44
  v_lshlrev_b32 v117, 2, v117
  v_mad_u32_u24 v44, v116, 48, v117
  v_lshl_or_b32 v18, v118, 19, v18
  ds_add_rtn_u32 v84, v44, v2 offset:0
  v_not_b32 v18, v18
  v_mul_hi_u32_u24 v116, s55, v45
  v_mul_hi_u32_u24 v117, s56, v19
  v_mad_i32_i24 v118, v116, s57, v45
  v_lshlrev_b32 v117, 2, v117
  v_mad_u32_u24 v45, v116, 48, v117
  v_lshl_or_b32 v19, v118, 19, v19
  ds_add_rtn_u32 v85, v45, v2 offset:0
  v_not_b32 v19, v19
  v_lshlrev_b32 v119, 16, v64
  v_and_b32 v120, 0xffff0000, v64
  v_mul_f32 v119, v3, v119
  v_mul_f32 v120, v3, v120
  v_cvt_pk_bf16_f32 v121, v119, v120
  v_lshlrev_b32 v119, 16, v121
  v_and_b32 v120, 0xffff0000, v121
  v_mul_f32 v119, 0.15915494, v119
  v_mul_f32 v120, 0.15915494, v120
  v_fract_f32 v119, v119
  v_fract_f32 v120, v120
  v_cos_f32 v119, v119
  v_cos_f32 v120, v120
  s_nop 0
  v_cvt_pk_bf16_f32 v64, v119, v120
  v_and_b32 v119, 0x7fff7fff, v64
  v_pk_max_u16 v124, v124, v119
  v_lshlrev_b32 v119, 16, v65
  v_and_b32 v120, 0xffff0000, v65
  v_mul_f32 v119, v3, v119
  v_mul_f32 v120, v3, v120
  v_cvt_pk_bf16_f32 v121, v119, v120
  v_lshlrev_b32 v119, 16, v121
  v_and_b32 v120, 0xffff0000, v121
  v_mul_f32 v119, 0.15915494, v119
  v_mul_f32 v120, 0.15915494, v120
  v_fract_f32 v119, v119
  v_fract_f32 v120, v120
  v_cos_f32 v119, v119
  v_cos_f32 v120, v120
  s_nop 0
  v_cvt_pk_bf16_f32 v65, v119, v120
  v_and_b32 v119, 0x7fff7fff, v65
  v_pk_max_u16 v124, v124, v119
  s_waitcnt vmcnt(9)
  v_mul_hi_u32_u24 v116, s55, v46
  v_mul_hi_u32_u24 v117, s56, v20
  v_mad_i32_i24 v118, v116, s57, v46
  v_lshlrev_b32 v117, 2, v117
  v_mad_u32_u24 v46, v116, 48, v117
  v_lshl_or_b32 v20, v118, 19, v20
  ds_add_rtn_u32 v86, v46, v2 offset:0
  v_not_b32 v20, v20
  v_mul_hi_u32_u24 v116, s55, v47
  v_mul_hi_u32_u24 v117, s56, v21
  v_mad_i32_i24 v118, v116, s57, v47
  v_lshlrev_b32 v117, 2, v117
  v_mad_u32_u24 v47, v116, 48, v117
  v_lshl_or_b32 v21, v118, 19, v21
  ds_add_rtn_u32 v87, v47, v2 offset:0
  v_not_b32 v21, v21
  v_mul_hi_u32_u24 v116, s55, v48
  v_mul_hi_u32_u24 v117, s56, v22
  v_mad_i32_i24 v118, v116, s57, v48
  v_lshlrev_b32 v117, 2, v117
  v_mad_u32_u24 v48, v116, 48, v117
  v_lshl_or_b32 v22, v118, 19, v22
  ds_add_rtn_u32 v88, v48, v2 offset:0
  v_not_b32 v22, v22
  v_mul_hi_u32_u24 v116, s55, v49
  v_mul_hi_u32_u24 v117, s56, v23
  v_mad_i32_i24 v118, v116, s57, v49
  v_lshlrev_b32 v117, 2, v117
  v_mad_u32_u24 v49, v116, 48, v117
  v_lshl_or_b32 v23, v118, 19, v23
  ds_add_rtn_u32 v89, v49, v2 offset:0
  v_not_b32 v23, v23
  v_lshlrev_b32 v119, 16, v66
  v_and_b32 v120, 0xffff0000, v66
  v_mul_f32 v119, v3, v119
  v_mul_f32 v120, v3, v120
  v_cvt_pk_bf16_f32 v121, v119, v120
  v_lshlrev_b32 v119, 16, v121
  v_and_b32 v120, 0xffff0000, v121
  v_mul_f32 v119, 0.15915494, v119
  v_mul_f32 v120, 0.15915494, v120
  v_fract_f32 v119, v119
  v_fract_f32 v120, v120
  v_cos_f32 v119, v119
  v_cos_f32 v120, v120
  s_nop 0
  v_cvt_pk_bf16_f32 v66, v119, v120
  v_and_b32 v119, 0x7fff7fff, v66
  v_pk_max_u16 v124, v124, v119
  v_lshlrev_b32 v119, 16, v67
  v_and_b32 v120, 0xffff0000, v67
  v_mul_f32 v119, v3, v119
  v_mul_f32 v120, v3, v120
  v_cvt_pk_bf16_f32 v121, v119, v120
  v_lshlrev_b32 v119, 16, v121
  v_and_b32 v120, 0xffff0000, v121
  v_mul_f32 v119, 0.15915494, v119
  v_mul_f32 v120, 0.15915494, v120
  v_fract_f32 v119, v119
  v_fract_f32 v120, v120
  v_cos_f32 v119, v119
  v_cos_f32 v120, v120
  s_nop 0
  v_cvt_pk_bf16_f32 v67, v119, v120
  v_and_b32 v119, 0x7fff7fff, v67
  v_pk_max_u16 v124, v124, v119
  s_waitcnt vmcnt(6)
  v_mul_hi_u32_u24 v116, s55, v50
  v_mul_hi_u32_u24 v117, s56, v24
  v_mad_i32_i24 v118, v116, s57, v50
  v_lshlrev_b32 v117, 2, v117
  v_mad_u32_u24 v50, v116, 48, v117
  v_lshl_or_b32 v24, v118, 19, v24
  ds_add_rtn_u32 v90, v50, v2 offset:0
  v_not_b32 v24, v24
  v_mul_hi_u32_u24 v116, s55, v51
  v_mul_hi_u32_u24 v117, s56, v25
  v_mad_i32_i24 v118, v116, s57, v51
  v_lshlrev_b32 v117, 2, v117
  v_mad_u32_u24 v51, v116, 48, v117
  v_lshl_or_b32 v25, v118, 19, v25
  ds_add_rtn_u32 v91, v51, v2 offset:0
  v_not_b32 v25, v25
  v_mul_hi_u32_u24 v116, s55, v52
  v_mul_hi_u32_u24 v117, s56, v26
  v_mad_i32_i24 v118, v116, s57, v52
  v_lshlrev_b32 v117, 2, v117
  v_mad_u32_u24 v52, v116, 48, v117
  v_lshl_or_b32 v26, v118, 19, v26
  ds_add_rtn_u32 v92, v52, v2 offset:0
  v_not_b32 v26, v26
  v_mul_hi_u32_u24 v116, s55, v53
  v_mul_hi_u32_u24 v117, s56, v27
  v_mad_i32_i24 v118, v116, s57, v53
  v_lshlrev_b32 v117, 2, v117
  v_mad_u32_u24 v53, v116, 48, v117
  v_lshl_or_b32 v27, v118, 19, v27
  ds_add_rtn_u32 v93, v53, v2 offset:0
  v_not_b32 v27, v27
  v_lshlrev_b32 v119, 16, v68
  v_and_b32 v120, 0xffff0000, v68
  v_mul_f32 v119, v3, v119
  v_mul_f32 v120, v3, v120
  v_cvt_pk_bf16_f32 v121, v119, v120
  v_lshlrev_b32 v119, 16, v121
  v_and_b32 v120, 0xffff0000, v121
  v_mul_f32 v119, 0.15915494, v119
  v_mul_f32 v120, 0.15915494, v120
  v_fract_f32 v119, v119
  v_fract_f32 v120, v120
  v_cos_f32 v119, v119
  v_cos_f32 v120, v120
  s_nop 0
  v_cvt_pk_bf16_f32 v68, v119, v120
  v_and_b32 v119, 0x7fff7fff, v68
  v_pk_max_u16 v124, v124, v119
  v_lshlrev_b32 v119, 16, v69
  v_and_b32 v120, 0xffff0000, v69
  v_mul_f32 v119, v3, v119
  v_mul_f32 v120, v3, v120
  v_cvt_pk_bf16_f32 v121, v119, v120
  v_lshlrev_b32 v119, 16, v121
  v_and_b32 v120, 0xffff0000, v121
  v_mul_f32 v119, 0.15915494, v119
  v_mul_f32 v120, 0.15915494, v120
  v_fract_f32 v119, v119
  v_fract_f32 v120, v120
  v_cos_f32 v119, v119
  v_cos_f32 v120, v120
  s_nop 0
  v_cvt_pk_bf16_f32 v69, v119, v120
  v_and_b32 v119, 0x7fff7fff, v69
  v_pk_max_u16 v124, v124, v119
  s_waitcnt vmcnt(3)
  v_mul_hi_u32_u24 v116, s55, v54
  v_mul_hi_u32_u24 v117, s56, v28
  v_mad_i32_i24 v118, v116, s57, v54
  v_lshlrev_b32 v117, 2, v117
  v_mad_u32_u24 v54, v116, 48, v117
  v_lshl_or_b32 v28, v118, 19, v28
  ds_add_rtn_u32 v94, v54, v2 offset:0
  v_not_b32 v28, v28
  v_mul_hi_u32_u24 v116, s55, v55
  v_mul_hi_u32_u24 v117, s56, v29
  v_mad_i32_i24 v118, v116, s57, v55
  v_lshlrev_b32 v117, 2, v117
  v_mad_u32_u24 v55, v116, 48, v117
  v_lshl_or_b32 v29, v118, 19, v29
  ds_add_rtn_u32 v95, v55, v2 offset:0
  v_not_b32 v29, v29
  v_mul_hi_u32_u24 v116, s55, v56
  v_mul_hi_u32_u24 v117, s56, v30
  v_mad_i32_i24 v118, v116, s57, v56
  v_lshlrev_b32 v117, 2, v117
  v_mad_u32_u24 v56, v116, 48, v117
  v_lshl_or_b32 v30, v118, 19, v30
  ds_add_rtn_u32 v96, v56, v2 offset:0
  v_not_b32 v30, v30
  v_mul_hi_u32_u24 v116, s55, v57
  v_mul_hi_u32_u24 v117, s56, v31
  v_mad_i32_i24 v118, v116, s57, v57
  v_lshlrev_b32 v117, 2, v117
  v_mad_u32_u24 v57, v116, 48, v117
  v_lshl_or_b32 v31, v118, 19, v31
  ds_add_rtn_u32 v97, v57, v2 offset:0
  v_not_b32 v31, v31
  v_lshlrev_b32 v119, 16, v70
  v_and_b32 v120, 0xffff0000, v70
  v_mul_f32 v119, v3, v119
  v_mul_f32 v120, v3, v120
  v_cvt_pk_bf16_f32 v121, v119, v120
  v_lshlrev_b32 v119, 16, v121
  v_and_b32 v120, 0xffff0000, v121
  v_mul_f32 v119, 0.15915494, v119
  v_mul_f32 v120, 0.15915494, v120
  v_fract_f32 v119, v119
  v_fract_f32 v120, v120
  v_cos_f32 v119, v119
  v_cos_f32 v120, v120
  s_nop 0
  v_cvt_pk_bf16_f32 v70, v119, v120
  v_and_b32 v119, 0x7fff7fff, v70
  v_pk_max_u16 v124, v124, v119
  v_lshlrev_b32 v119, 16, v71
  v_and_b32 v120, 0xffff0000, v71
  v_mul_f32 v119, v3, v119
  v_mul_f32 v120, v3, v120
  v_cvt_pk_bf16_f32 v121, v119, v120
  v_lshlrev_b32 v119, 16, v121
  v_and_b32 v120, 0xffff0000, v121
  v_mul_f32 v119, 0.15915494, v119
  v_mul_f32 v120, 0.15915494, v120
  v_fract_f32 v119, v119
  v_fract_f32 v120, v120
  v_cos_f32 v119, v119
  v_cos_f32 v120, v120
  s_nop 0
  v_cvt_pk_bf16_f32 v71, v119, v120
  v_and_b32 v119, 0x7fff7fff, v71
  v_pk_max_u16 v124, v124, v119
  s_waitcnt vmcnt(0)
  v_cmp_gt_u32 vcc, s59, v0
  s_and_saveexec_b64 s[62:63], vcc
  s_cbranch_execz LA_r24
  v_mul_hi_u32_u24 v116, s55, v58
  v_mul_hi_u32_u24 v117, s56, v32
  v_mad_i32_i24 v118, v116, s57, v58
  v_lshlrev_b32 v117, 2, v117
  v_mad_u32_u24 v58, v116, 48, v117
  v_lshl_or_b32 v32, v118, 19, v32
  ds_add_rtn_u32 v98, v58, v2 offset:0
  v_not_b32 v32, v32
  v_lshlrev_b32 v119, 16, v72
  v_and_b32 v120, 0xffff0000, v72
  v_mul_f32 v119, v3, v119
  v_mul_f32 v120, v3, v120
  v_cvt_pk_bf16_f32 v121, v119, v120
  v_lshlrev_b32 v119, 16, v121
  v_and_b32 v120, 0xffff0000, v121
  v_mul_f32 v119, 0.15915494, v119
  v_mul_f32 v120, 0.15915494, v120
  v_fract_f32 v119, v119
  v_fract_f32 v120, v120
  v_cos_f32 v119, v119
  v_cos_f32 v120, v120
  s_nop 0
  v_cvt_pk_bf16_f32 v72, v119, v120
  v_and_b32 v119, 0x7fff7fff, v72
  v_pk_max_u16 v124, v124, v119
LA_r24:
  s_mov_b64 exec, s[62:63]
  s_waitcnt lgkmcnt(0)
  s_barrier
  s_mov_b32 s53, 0
  buffer_load_dwordx4 v[100:103], v4, s[28:31], s53 offen
  ds_read2_b32 v[116:117], v126 offset0:0 offset1:1
  ds_read_b32 v125, v126 offset:8
  s_waitcnt lgkmcnt(0)
  v_add3_u32 v118, v116, v117, v125
  v_mov_b32 v119, v118
  s_nop 1
  v_add_u32_dpp v119, v119, v119 row_shr:1 row_mask:0xf bank_mask:0xf
  s_nop 1
  v_add_u32_dpp v119, v119, v119 row_shr:2 row_mask:0xf bank_mask:0xf
  s_nop 1
  v_add_u32_dpp v119, v119, v119 row_shr:4 row_mask:0xf bank_mask:0xf
  s_nop 1
  v_add_u32_dpp v119, v119, v119 row_shr:8 row_mask:0xf bank_mask:0xf
  s_nop 1
  v_add_u32_dpp v119, v119, v119 row_bcast:15 row_mask:0xa bank_mask:0xf
  s_nop 1
  v_add_u32_dpp v119, v119, v119 row_bcast:31 row_mask:0xc bank_mask:0xf
  s_lshl_b32 s58, s50, 2
  s_add_u32 s58, s58, 162432
  v_mov_b32 v120, s58
  s_mov_b32 exec_lo, 0
  s_mov_b32 exec_hi, 0x80000000
  ds_write_b32 v120, v119
  s_mov_b64 exec, -1
  s_waitcnt lgkmcnt(0)
  s_barrier
  v_and_b32 v120, 15, v0
  v_lshlrev_b32 v120, 2, v120
  v_add_u32 v120, 162432, v120
  ds_read_b32 v120, v120
  s_waitcnt lgkmcnt(0)
  v_mov_b32 v121, v120
  s_nop 1
  v_add_u32_dpp v121, v121, v121 row_shr:1 row_mask:0xf bank_mask:0xf
  s_nop 1
  v_add_u32_dpp v121, v121, v121 row_shr:2 row_mask:0xf bank_mask:0xf
  s_nop 1
  v_add_u32_dpp v121, v121, v121 row_shr:4 row_mask:0xf bank_mask:0xf
  s_nop 1
  v_add_u32_dpp v121, v121, v121 row_shr:8 row_mask:0xf bank_mask:0xf
  v_sub_u32 v121, v121, v120
  s_nop 0
  v_readlane_b32 s58, v121, s50
  v_sub_u32 v119, v119, v118
  s_nop 0
  v_add_u32 v118, s58, v119
  v_add_u32 v119, v118, v116
  v_add_u32 v125, v119, v117
  ds_write2_b32 v126, v118, v119 offset0:0 offset1:1
  ds_write_b32 v126, v125 offset:8
  v_and_b32 v120, 3, v0
  v_cmp_eq_u32 vcc, 0, v120
  s_and_saveexec_b64 s[60:61], vcc
  v_lshrrev_b32 v118, 1, v118
  buffer_store_dword v118, v0, s[40:43], 0 offen sc0 sc1
  s_mov_b64 exec, s[60:61]
  s_waitcnt lgkmcnt(0)
  s_barrier
  s_mov_b32 s53, 16384
  buffer_load_dwordx4 v[104:107], v4, s[28:31], s53 offen
  ds_read_b32 v34, v34 offset:0
  ds_read_b32 v35, v35 offset:0
  ds_read_b32 v36, v36 offset:0
  ds_read_b32 v37, v37 offset:0
  ds_read_b32 v38, v38 offset:0
  ds_read_b32 v39, v39 offset:0
  ds_read_b32 v40, v40 offset:0
  ds_read_b32 v41, v41 offset:0
  ds_read_b32 v42, v42 offset:0
  ds_read_b32 v43, v43 offset:0
  ds_read_b32 v44, v44 offset:0
  ds_read_b32 v45, v45 offset:0
  ds_read_b32 v46, v46 offset:0
  ds_read_b32 v47, v47 offset:0
  ds_read_b32 v48, v48 offset:0
  ds_read_b32 v49, v49 offset:0
  ds_read_b32 v50, v50 offset:0
  ds_read_b32 v51, v51 offset:0
  ds_read_b32 v52, v52 offset:0
  ds_read_b32 v53, v53 offset:0
  ds_read_b32 v54, v54 offset:0
  ds_read_b32 v55, v55 offset:0
  ds_read_b32 v56, v56 offset:0
  ds_read_b32 v57, v57 offset:0
  v_cmp_gt_u32 vcc, s59, v0
  s_and_saveexec_b64 s[62:63], vcc
  s_cbranch_execz LA_s24
  ds_read_b32 v58, v58 offset:0
  s_waitcnt lgkmcnt(0)
  v_add_u32 v58, v58, v98
  v_lshlrev_b32 v98, 1, v58
  ds_write_b32 v98, v32 offset:62336
  ds_write_b16 v58, v72 offset:12288
LA_s24:
  s_mov_b64 exec, s[62:63]
  s_waitcnt lgkmcnt(0)
  v_add_u32 v34, v34, v74
  v_lshlrev_b32 v74, 1, v34
  ds_write_b32 v74, v8 offset:62336
  ds_write_b16 v34, v60 offset:12288
  v_add_u32 v35, v35, v75
  v_lshlrev_b32 v75, 1, v35
  ds_write_b32 v75, v9 offset:62336
  ds_write_b16_d16_hi v35, v60 offset:12288
  v_add_u32 v36, v36, v76
  v_lshlrev_b32 v76, 1, v36
  ds_write_b32 v76, v10 offset:62336
  ds_write_b16 v36, v61 offset:12288
  v_add_u32 v37, v37, v77
  v_lshlrev_b32 v77, 1, v37
  ds_write_b32 v77, v11 offset:62336
  ds_write_b16_d16_hi v37, v61 offset:12288
  v_add_u32 v38, v38, v78
  v_lshlrev_b32 v78, 1, v38
  ds_write_b32 v78, v12 offset:62336
  ds_write_b16 v38, v62 offset:12288
  v_add_u32 v39, v39, v79
  v_lshlrev_b32 v79, 1, v39
  ds_write_b32 v79, v13 offset:62336
  ds_write_b16_d16_hi v39, v62 offset:12288
  v_add_u32 v40, v40, v80
  v_lshlrev_b32 v80, 1, v40
  ds_write_b32 v80, v14 offset:62336
  ds_write_b16 v40, v63 offset:12288
  v_add_u32 v41, v41, v81
  v_lshlrev_b32 v81, 1, v41
  ds_write_b32 v81, v15 offset:62336
  ds_write_b16_d16_hi v41, v63 offset:12288
  v_add_u32 v42, v42, v82
  v_lshlrev_b32 v82, 1, v42
  ds_write_b32 v82, v16 offset:62336
  ds_write_b16 v42, v64 offset:12288
  v_add_u32 v43, v43, v83
  v_lshlrev_b32 v83, 1, v43
  ds_write_b32 v83, v17 offset:62336
  ds_write_b16_d16_hi v43, v64 offset:12288
  v_add_u32 v44, v44, v84
  v_lshlrev_b32 v84, 1, v44
  ds_write_b32 v84, v18 offset:62336
  ds_write_b16 v44, v65 offset:12288
  v_add_u32 v45, v45, v85
  v_lshlrev_b32 v85, 1, v45
  ds_write_b32 v85, v19 offset:62336
  ds_write_b16_d16_hi v45, v65 offset:12288
  s_mov_b32 s53, 32768
  buffer_load_dwordx4 v[108:111], v4, s[28:31], s53 offen
  s_mov_b32 s53, 49152
  buffer_load_dwordx4 v[112:115], v4, s[28:31], s53 offen
  v_add_u32 v46, v46, v86
  v_lshlrev_b32 v86, 1, v46
  ds_write_b32 v86, v20 offset:62336
  ds_write_b16 v46, v66 offset:12288
  v_add_u32 v47, v47, v87
  v_lshlrev_b32 v87, 1, v47
  ds_write_b32 v87, v21 offset:62336
  ds_write_b16_d16_hi v47, v66 offset:12288
  v_add_u32 v48, v48, v88
  v_lshlrev_b32 v88, 1, v48
  ds_write_b32 v88, v22 offset:62336
  ds_write_b16 v48, v67 offset:12288
  v_add_u32 v49, v49, v89
  v_lshlrev_b32 v89, 1, v49
  ds_write_b32 v89, v23 offset:62336
  ds_write_b16_d16_hi v49, v67 offset:12288
  v_add_u32 v50, v50, v90
  v_lshlrev_b32 v90, 1, v50
  ds_write_b32 v90, v24 offset:62336
  ds_write_b16 v50, v68 offset:12288
  v_add_u32 v51, v51, v91
  v_lshlrev_b32 v91, 1, v51
  ds_write_b32 v91, v25 offset:62336
  ds_write_b16_d16_hi v51, v68 offset:12288
  v_add_u32 v52, v52, v92
  v_lshlrev_b32 v92, 1, v52
  ds_write_b32 v92, v26 offset:62336
  ds_write_b16 v52, v69 offset:12288
  v_add_u32 v53, v53, v93
  v_lshlrev_b32 v93, 1, v53
  ds_write_b32 v93, v27 offset:62336
  ds_write_b16_d16_hi v53, v69 offset:12288
  v_add_u32 v54, v54, v94
  v_lshlrev_b32 v94, 1, v54
  ds_write_b32 v94, v28 offset:62336
  ds_write_b16 v54, v70 offset:12288
  v_add_u32 v55, v55, v95
  v_lshlrev_b32 v95, 1, v55
  ds_write_b32 v95, v29 offset:62336
  ds_write_b16_d16_hi v55, v70 offset:12288
  v_add_u32 v56, v56, v96
  v_lshlrev_b32 v96, 1, v56
  ds_write_b32 v96, v30 offset:62336
  ds_write_b16 v56, v71 offset:12288
  v_add_u32 v57, v57, v97
  v_lshlrev_b32 v97, 1, v57
  ds_write_b32 v97, v31 offset:62336
  ds_write_b16_d16_hi v57, v71 offset:12288
  s_waitcnt lgkmcnt(0)
  s_barrier
  v_add_u32 v116, 0, v4
  ds_read_b128 v[8:11], v116 offset:62336
  v_add_u32 v116, 16384, v4
  ds_read_b128 v[12:15], v116 offset:62336
  v_add_u32 v116, 32768, v4
  ds_read_b128 v[16:19], v116 offset:62336
  v_add_u32 v116, 49152, v4
  ds_read_b128 v[20:23], v116 offset:62336
  v_add_u32 v116, 65536, v4
  ds_read_b128 v[24:27], v116 offset:62336
  v_add_u32 v116, 81920, v4
  ds_read_b128 v[28:31], v116 offset:62336
  v_add_u32 v116, 0, v4
  ds_read_b128 v[32:35], v116 offset:12288
  v_add_u32 v116, 16384, v4
  ds_read_b128 v[36:39], v116 offset:12288
  v_add_u32 v116, 32768, v4
  ds_read_b128 v[40:43], v116 offset:12288
  s_mov_b32 s53, 0
  s_waitcnt lgkmcnt(8)
  buffer_store_dwordx4 v[8:11], v4, s[32:35], s53 offen sc0 sc1
  s_mov_b32 s53, 16384
  s_waitcnt lgkmcnt(7)
  buffer_store_dwordx4 v[12:15], v4, s[32:35], s53 offen sc0 sc1
  s_mov_b32 s53, 32768
  s_waitcnt lgkmcnt(6)
  buffer_store_dwordx4 v[16:19], v4, s[32:35], s53 offen sc0 sc1
  s_mov_b32 s53, 49152
  s_waitcnt lgkmcnt(5)
  buffer_store_dwordx4 v[20:23], v4, s[32:35], s53 offen sc0 sc1
  s_mov_b32 s53, 65536
  s_waitcnt lgkmcnt(4)
  buffer_store_dwordx4 v[24:27], v4, s[32:35], s53 offen sc0 sc1
  s_mov_b32 s53, 81920
  s_waitcnt lgkmcnt(3)
  buffer_store_dwordx4 v[28:31], v4, s[32:35], s53 offen sc0 sc1
  s_mov_b32 s53, 0
  s_waitcnt lgkmcnt(2)
  buffer_store_dwordx4 v[32:35], v4, s[36:39], s53 offen sc0 sc1
  s_mov_b32 s53, 16384
  s_waitcnt lgkmcnt(1)
  buffer_store_dwordx4 v[36:39], v4, s[36:39], s53 offen sc0 sc1
  s_mov_b32 s53, 32768
  s_waitcnt lgkmcnt(0)
  buffer_store_dwordx4 v[40:43], v4, s[36:39], s53 offen sc0 sc1
  s_cmp_lt_u32 s50, 2
  s_cbranch_scc0 LA_t1
  v_add_u32 v116, 98304, v4
  ds_read_b128 v[60:63], v116 offset:62336
  s_mov_b32 s53, 98304
  s_waitcnt lgkmcnt(0)
  buffer_store_dwordx4 v[60:63], v4, s[32:35], s53 offen sc0 sc1
LA_t1:
  s_cmp_lt_u32 s50, 1
  s_cbranch_scc0 LA_t2
  v_add_u32 v116, 49152, v4
  ds_read_b128 v[64:67], v116 offset:12288
  s_mov_b32 s53, 49152
  s_waitcnt lgkmcnt(0)
  buffer_store_dwordx4 v[64:67], v4, s[36:39], s53 offen sc0 sc1
LA_t2:
  s_waitcnt vmcnt(9)
  v_mov_b32 v122, 0
  v_mov_b32 v123, 0
  s_mov_b32 s58, 0x7fff7fff
  v_and_b32 v100, s58, v100
  v_and_b32 v101, s58, v101
  v_and_b32 v102, s58, v102
  v_and_b32 v103, s58, v103
  v_pk_max_u16 v100, v100, v101
  v_pk_max_u16 v102, v102, v103
  v_pk_max_u16 v100, v100, v102
  v_lshrrev_b32 v101, 16, v100
  v_and_b32 v100, 0xffff, v100
  v_max_u32 v100, v100, v101
  s_nop 1
  v_max_u32_dpp v100, v100, v100 quad_perm:[1,0,3,2] row_mask:0xf bank_mask:0xf
  v_max_u32 v122, v122, v100
  v_sub_u32 v100, 0x8000, v100
  v_and_b32 v100, 0x7fff, v100
  v_max_u32 v123, v123, v100
  v_and_b32 v104, s58, v104
  v_and_b32 v105, s58, v105
  v_and_b32 v106, s58, v106
  v_and_b32 v107, s58, v107
  v_pk_max_u16 v104, v104, v105
  v_pk_max_u16 v106, v106, v107
  v_pk_max_u16 v104, v104, v106
  v_lshrrev_b32 v105, 16, v104
  v_and_b32 v104, 0xffff, v104
  v_max_u32 v104, v104, v105
  s_nop 1
  v_max_u32_dpp v104, v104, v104 quad_perm:[1,0,3,2] row_mask:0xf bank_mask:0xf
  v_max_u32 v122, v122, v104
  v_sub_u32 v104, 0x8000, v104
  v_and_b32 v104, 0x7fff, v104
  v_max_u32 v123, v123, v104
  v_and_b32 v108, s58, v108
  v_and_b32 v109, s58, v109
  v_and_b32 v110, s58, v110
  v_and_b32 v111, s58, v111
  v_pk_max_u16 v108, v108, v109
  v_pk_max_u16 v110, v110, v111
  v_pk_max_u16 v108, v108, v110
  v_lshrrev_b32 v109, 16, v108
  v_and_b32 v108, 0xffff, v108
  v_max_u32 v108, v108, v109
  s_nop 1
  v_max_u32_dpp v108, v108, v108 quad_perm:[1,0,3,2] row_mask:0xf bank_mask:0xf
  v_max_u32 v122, v122, v108
  v_sub_u32 v108, 0x8000, v108
  v_and_b32 v108, 0x7fff, v108
  v_max_u32 v123, v123, v108
  v_and_b32 v112, s58, v112
  v_and_b32 v113, s58, v113
  v_and_b32 v114, s58, v114
  v_and_b32 v115, s58, v115
  v_pk_max_u16 v112, v112, v113
  v_pk_max_u16 v114, v114, v115
  v_pk_max_u16 v112, v112, v114
  v_lshrrev_b32 v113, 16, v112
  v_and_b32 v112, 0xffff, v112
  v_max_u32 v112, v112, v113
  s_nop 1
  v_max_u32_dpp v112, v112, v112 quad_perm:[1,0,3,2] row_mask:0xf bank_mask:0xf
  v_max_u32 v122, v122, v112
  v_sub_u32 v112, 0x8000, v112
  v_and_b32 v112, 0x7fff, v112
  v_max_u32 v123, v123, v112
  v_lshrrev_b32 v121, 16, v124
  v_and_b32 v124, 0xffff, v124
  v_max_u32 v124, v124, v121
  v_cmp_lt_u32 vcc, 0x3f80, v124
  v_mov_b32 v121, 0x7fff
  s_nop 0
  v_cndmask_b32 v121, 0, v121, vcc
  v_max_u32 v122, v122, v121
  s_nop 1
  v_max_u32_dpp v122, v122, v122 row_shr:1 row_mask:0xf bank_mask:0xf
  v_max_u32_dpp v123, v123, v123 row_shr:1 row_mask:0xf bank_mask:0xf
  s_nop 1
  v_max_u32_dpp v122, v122, v122 row_shr:2 row_mask:0xf bank_mask:0xf
  v_max_u32_dpp v123, v123, v123 row_shr:2 row_mask:0xf bank_mask:0xf
  s_nop 1
  v_max_u32_dpp v122, v122, v122 row_shr:4 row_mask:0xf bank_mask:0xf
  v_max_u32_dpp v123, v123, v123 row_shr:4 row_mask:0xf bank_mask:0xf
  s_nop 1
  v_max_u32_dpp v122, v122, v122 row_shr:8 row_mask:0xf bank_mask:0xf
  v_max_u32_dpp v123, v123, v123 row_shr:8 row_mask:0xf bank_mask:0xf
  s_nop 1
  v_max_u32_dpp v122, v122, v122 row_bcast:15 row_mask:0xa bank_mask:0xf
  v_max_u32_dpp v123, v123, v123 row_bcast:15 row_mask:0xa bank_mask:0xf
  s_nop 1
  v_max_u32_dpp v122, v122, v122 row_bcast:31 row_mask:0xc bank_mask:0xf
  v_max_u32_dpp v123, v123, v123 row_bcast:31 row_mask:0xc bank_mask:0xf
  v_mov_b32 v120, 162496
  s_mov_b32 exec_lo, 0
  s_mov_b32 exec_hi, 0x80000000
  ds_max_u32 v120, v122
  ds_max_u32 v120, v123 offset:4
  s_mov_b64 exec, -1
  s_waitcnt lgkmcnt(0)
  s_barrier
  s_cmp_eq_u32 s50, 15
  s_cbranch_scc0 LA_end
  v_mov_b32 v120, 162496
  ds_read_b64 v[118:119], v120
  s_waitcnt lgkmcnt(0)
  v_mov_b32 v116, 0
  s_mov_b32 exec_lo, 1
  s_mov_b32 exec_hi, 0
  buffer_store_dwordx2 v[118:119], v116, s[44:47], 0 offen sc0 sc1
LA_end:
  s_endpgm
.globl standalone__molecular_angular_gemnet__graph_kernel
.p2align 8
.type standalone__molecular_angular_gemnet__graph_kernel,@function
standalone__molecular_angular_gemnet__graph_kernel:
  s_cmp_ge_u32 s2, 256
  s_cbranch_scc1 LB_end
  s_and_b32 s3, s2, 7
  s_lshr_b32 s2, s2, 3
  s_mul_i32 s4, s3, 32
  s_add_u32 s2, s2, s4
  s_load_dwordx2 s[78:79], s[0:1], 104
  s_load_dwordx2 s[68:69], s[0:1], 0
  s_load_dwordx2 s[70:71], s[0:1], 24
  s_load_dwordx2 s[40:41], s[0:1], 40
  s_load_dwordx4 s[44:47], s[0:1], 56
  s_load_dwordx4 s[72:75], s[0:1], 72
  s_load_dwordx2 s[76:77], s[0:1], 88
  v_lshrrev_b32 v8, 6, v0
  v_and_b32 v77, 15, v0
  v_readfirstlane_b32 s50, v8
  v_and_b32 v9, 1, v0
  v_lshlrev_b32 v1, 3, v9
  v_lshlrev_b32 v3, 4, v9
  v_lshlrev_b32 v5, 4, v9
  v_mov_b32 v6, 163760
  v_mov_b32 v7, 1
  s_mul_i32 s80, s2, 50048
  s_mul_i32 s81, s2, 3128
  s_mov_b32 s56, 0
  s_mov_b32 s57, 0x7ffff
  s_mov_b32 s58, -80
  s_mov_b32 s60, 0x05040100
  s_waitcnt lgkmcnt(0)
  s_add_u32 s82, s78, 38437120
  s_addc_u32 s83, s79, 0
  s_mov_b32 s16, s82
  s_and_b32 s17, s83, 0xffff
  s_mov_b32 s18, 262144
  s_mov_b32 s19, 0x20000
  s_add_u32 s82, s78, 38699264
  s_addc_u32 s83, s79, 0
  s_mov_b32 s20, s82
  s_and_b32 s21, s83, 0xffff
  s_mov_b32 s22, 2048
  s_mov_b32 s23, 0x20000
  s_add_u32 s82, s78, 252
  s_addc_u32 s83, s79, 0
  s_mov_b32 s4, s82
  s_and_b32 s5, s83, 0xffff
  s_or_b32 s5, s5, 0x40000
  s_mov_b32 s6, 6406145
  s_mov_b32 s7, 0x20000
  s_add_u32 s82, s78, 25624830
  s_addc_u32 s83, s79, 0
  s_mov_b32 s8, s82
  s_and_b32 s9, s83, 0xffff
  s_or_b32 s9, s9, 0x20000
  s_mov_b32 s10, 6406145
  s_mov_b32 s11, 0x20000
  s_mov_b32 s12, s68
  s_and_b32 s13, s69, 0xffff
  s_or_b32 s13, s13, 0x200000
  s_mov_b32 s14, 400000
  s_mov_b32 s15, 0x20000
  s_add_u32 s24, s68, s80
  s_addc_u32 s25, s69, 0
  s_and_b32 s25, s25, 0xffff
  s_mov_b32 s26, 50048
  s_mov_b32 s27, 0x20000
  s_add_u32 s28, s76, s80
  s_addc_u32 s29, s77, 0
  s_and_b32 s29, s29, 0xffff
  s_mov_b32 s30, 50048
  s_mov_b32 s31, 0x20000
  s_add_u32 s32, s70, s81
  s_addc_u32 s33, s71, 0
  s_and_b32 s33, s33, 0xffff
  s_mov_b32 s34, 3128
  s_mov_b32 s35, 0x20000
  s_sub_u32 s82, 12800000, s80
  s_min_u32 s26, s82, 50048
  s_mov_b32 s30, s26
  s_lshr_b32 s34, s26, 4
LB_start:
  s_setprio 3
  v_and_b32 v57, 63, v0
  v_lshrrev_b32 v56, 4, v57
  s_lshl_b32 s80, s50, 4
  v_add_u32 v57, s80, v56
  s_lshl_b32 s81, s2, 2
  v_lshlrev_b32 v58, 10, v57
  v_add_u32 v58, s81, v58
  v_add_u32 v59, 0, v58
  buffer_load_dwordx2 v[8:9], v59, s[16:19], 0 offen
  v_add_u32 v59, 4096, v58
  buffer_load_dwordx2 v[10:11], v59, s[16:19], 0 offen
  v_add_u32 v59, 8192, v58
  buffer_load_dwordx2 v[12:13], v59, s[16:19], 0 offen
  v_add_u32 v59, 12288, v58
  buffer_load_dwordx2 v[14:15], v59, s[16:19], 0 offen
  v_and_b32 v59, 63, v0
  v_lshlrev_b32 v59, 3, v59
  buffer_load_dwordx2 v[48:49], v59, s[20:23], 0 offen offset:0
  buffer_load_dwordx2 v[50:51], v59, s[20:23], 0 offen offset:512
  buffer_load_dwordx2 v[52:53], v59, s[20:23], 0 offen offset:1024
  buffer_load_dwordx2 v[54:55], v59, s[20:23], 0 offen offset:1536
  v_mov_b32 v40, 0
  v_mov_b32 v41, 0
  v_mov_b32 v42, 0
  v_mov_b32 v43, 0
  v_lshlrev_b32 v59, 4, v0
  ds_write_b128 v59, v[40:43] offset:0
  ds_write_b128 v59, v[40:43] offset:16384
  ds_write_b128 v59, v[40:43] offset:32768
  ds_write_b128 v59, v[40:43] offset:49152
  v_add_u32 v59, 0x10000, v59
  ds_write_b128 v59, v[40:43] offset:0
  ds_write_b128 v59, v[40:43] offset:16384
  ds_write_b128 v59, v[40:43] offset:32768
  ds_write_b128 v59, v[40:43] offset:49152
  s_waitcnt vmcnt(4)
  s_mov_b32 s80, 25024
  v_add_u32 v59, 0, v57
  v_mad_u32_u24 v59, v59, s80, 1
  v_add_u32 v65, v59, v8
  s_cmp_eq_u32 s2, 255
  s_cbranch_scc0 LB_rp1_0
  v_add_u32 v60, 0, v57
  v_cmp_gt_u32 vcc, 160, v60
  v_mov_b32 v60, 25024
  v_mov_b32 v9, 24960
  v_cndmask_b32 v9, v9, v60, vcc
LB_rp1_0:
  v_sub_u32 v69, v9, v8
  v_add_u32 v59, 4, v57
  v_mad_u32_u24 v59, v59, s80, 1
  v_add_u32 v66, v59, v10
  s_cmp_eq_u32 s2, 255
  s_cbranch_scc0 LB_rp1_1
  v_add_u32 v60, 4, v57
  v_cmp_gt_u32 vcc, 160, v60
  v_mov_b32 v60, 25024
  v_mov_b32 v11, 24960
  v_cndmask_b32 v11, v11, v60, vcc
LB_rp1_1:
  v_sub_u32 v70, v11, v10
  v_add_u32 v59, 8, v57
  v_mad_u32_u24 v59, v59, s80, 1
  v_add_u32 v67, v59, v12
  s_cmp_eq_u32 s2, 255
  s_cbranch_scc0 LB_rp1_2
  v_add_u32 v60, 8, v57
  v_cmp_gt_u32 vcc, 160, v60
  v_mov_b32 v60, 25024
  v_mov_b32 v13, 24960
  v_cndmask_b32 v13, v13, v60, vcc
LB_rp1_2:
  v_sub_u32 v71, v13, v12
  v_add_u32 v59, 12, v57
  v_mad_u32_u24 v59, v59, s80, 1
  v_add_u32 v68, v59, v14
  s_cmp_eq_u32 s2, 255
  s_cbranch_scc0 LB_rp1_3
  v_add_u32 v60, 12, v57
  v_cmp_gt_u32 vcc, 160, v60
  v_mov_b32 v60, 25024
  v_mov_b32 v15, 24960
  v_cndmask_b32 v15, v15, v60, vcc
LB_rp1_3:
  v_sub_u32 v72, v15, v14
  v_max_u32 v59, v69, v70
  v_max3_u32 v59, v59, v71, v72
  v_cmp_lt_u32 vcc, 0x80, v59
  s_cmp_lg_u64 vcc, 0
  s_cselect_b32 s59, 1, 0
  v_cmp_lt_u32 vcc, 0x90, v59
  s_cmp_lg_u64 vcc, 0
  s_cselect_b32 s61, 1, 0
  v_min_u32 v58, 0x80, v69
  v_mov_b32 v60, v77
  v_lshlrev_b32 v58, 16, v58
  v_mul_hi_u32_u24 v62, 0x2000, v58
  v_cmp_lt_u32 vcc, v60, v62
  v_add_u32 v63, v65, v60
  v_add_u32 v60, v62, v77
  v_cndmask_b32 v96, 0, v63, vcc
  s_mov_b64 exec, vcc
  buffer_load_ushort v80, v96, s[8:11], 0 idxen
  buffer_load_dword v96, v96, s[4:7], 0 idxen
  s_mov_b64 exec, -1
  v_mul_hi_u32_u24 v62, 0x4000, v58
  v_cmp_lt_u32 vcc, v60, v62
  v_add_u32 v63, v65, v60
  v_add_u32 v60, v62, v77
  v_cndmask_b32 v100, 0, v63, vcc
  s_mov_b64 exec, vcc
  buffer_load_ushort v16, v100, s[8:11], 0 idxen
  buffer_load_dword v100, v100, s[4:7], 0 idxen
  s_mov_b64 exec, -1
  v_mul_hi_u32_u24 v62, 0x6000, v58
  v_cmp_lt_u32 vcc, v60, v62
  v_add_u32 v63, v65, v60
  v_add_u32 v60, v62, v77
  v_cndmask_b32 v104, 0, v63, vcc
  s_mov_b64 exec, vcc
  buffer_load_ushort v84, v104, s[8:11], 0 idxen
  buffer_load_dword v104, v104, s[4:7], 0 idxen
  s_mov_b64 exec, -1
  v_mul_hi_u32_u24 v62, 0x8000, v58
  v_cmp_lt_u32 vcc, v60, v62
  v_add_u32 v63, v65, v60
  v_add_u32 v60, v62, v77
  v_cndmask_b32 v108, 0, v63, vcc
  s_mov_b64 exec, vcc
  buffer_load_ushort v20, v108, s[8:11], 0 idxen
  buffer_load_dword v108, v108, s[4:7], 0 idxen
  s_mov_b64 exec, -1
  v_mul_hi_u32_u24 v62, 0xa000, v58
  v_cmp_lt_u32 vcc, v60, v62
  v_add_u32 v63, v65, v60
  v_add_u32 v60, v62, v77
  v_cndmask_b32 v112, 0, v63, vcc
  s_mov_b64 exec, vcc
  buffer_load_ushort v88, v112, s[8:11], 0 idxen
  buffer_load_dword v112, v112, s[4:7], 0 idxen
  s_mov_b64 exec, -1
  v_mul_hi_u32_u24 v62, 0xc000, v58
  v_cmp_lt_u32 vcc, v60, v62
  v_add_u32 v63, v65, v60
  v_add_u32 v60, v62, v77
  v_cndmask_b32 v116, 0, v63, vcc
  s_mov_b64 exec, vcc
  buffer_load_ushort v24, v116, s[8:11], 0 idxen
  buffer_load_dword v116, v116, s[4:7], 0 idxen
  s_mov_b64 exec, -1
  v_mul_hi_u32_u24 v62, 0xe000, v58
  v_cmp_lt_u32 vcc, v60, v62
  v_add_u32 v63, v65, v60
  v_add_u32 v60, v62, v77
  v_cndmask_b32 v120, 0, v63, vcc
  s_mov_b64 exec, vcc
  buffer_load_ushort v92, v120, s[8:11], 0 idxen
  buffer_load_dword v120, v120, s[4:7], 0 idxen
  s_mov_b64 exec, -1
  v_mul_hi_u32_u24 v62, 0x10000, v58
  v_cmp_lt_u32 vcc, v60, v62
  v_add_u32 v63, v65, v60
  v_add_u32 v60, v62, v77
  v_cndmask_b32 v124, 0, v63, vcc
  s_mov_b64 exec, vcc
  buffer_load_ushort v28, v124, s[8:11], 0 idxen
  buffer_load_dword v124, v124, s[4:7], 0 idxen
  s_mov_b64 exec, -1
  v_add_u32 v64, 0x80, v77
  v_cmp_lt_u32 vcc, v64, v69
  v_add_u32 v63, v65, v64
  s_nop 0
  v_cndmask_b32 v73, 0, v63, vcc
  v_min_u32 v58, 0x80, v70
  v_mov_b32 v60, v77
  v_lshlrev_b32 v58, 16, v58
  v_mul_hi_u32_u24 v62, 0x2000, v58
  v_cmp_lt_u32 vcc, v60, v62
  v_add_u32 v63, v66, v60
  v_add_u32 v60, v62, v77
  v_cndmask_b32 v97, 0, v63, vcc
  s_mov_b64 exec, vcc
  buffer_load_ushort v81, v97, s[8:11], 0 idxen
  buffer_load_dword v97, v97, s[4:7], 0 idxen
  s_mov_b64 exec, -1
  v_mul_hi_u32_u24 v62, 0x4000, v58
  v_cmp_lt_u32 vcc, v60, v62
  v_add_u32 v63, v66, v60
  v_add_u32 v60, v62, v77
  v_cndmask_b32 v101, 0, v63, vcc
  s_mov_b64 exec, vcc
  buffer_load_ushort v17, v101, s[8:11], 0 idxen
  buffer_load_dword v101, v101, s[4:7], 0 idxen
  s_mov_b64 exec, -1
  v_mul_hi_u32_u24 v62, 0x6000, v58
  v_cmp_lt_u32 vcc, v60, v62
  v_add_u32 v63, v66, v60
  v_add_u32 v60, v62, v77
  v_cndmask_b32 v105, 0, v63, vcc
  s_mov_b64 exec, vcc
  buffer_load_ushort v85, v105, s[8:11], 0 idxen
  buffer_load_dword v105, v105, s[4:7], 0 idxen
  s_mov_b64 exec, -1
  v_mul_hi_u32_u24 v62, 0x8000, v58
  v_cmp_lt_u32 vcc, v60, v62
  v_add_u32 v63, v66, v60
  v_add_u32 v60, v62, v77
  v_cndmask_b32 v109, 0, v63, vcc
  s_mov_b64 exec, vcc
  buffer_load_ushort v21, v109, s[8:11], 0 idxen
  buffer_load_dword v109, v109, s[4:7], 0 idxen
  s_mov_b64 exec, -1
  v_mul_hi_u32_u24 v62, 0xa000, v58
  v_cmp_lt_u32 vcc, v60, v62
  v_add_u32 v63, v66, v60
  v_add_u32 v60, v62, v77
  v_cndmask_b32 v113, 0, v63, vcc
  s_mov_b64 exec, vcc
  buffer_load_ushort v89, v113, s[8:11], 0 idxen
  buffer_load_dword v113, v113, s[4:7], 0 idxen
  s_mov_b64 exec, -1
  v_mul_hi_u32_u24 v62, 0xc000, v58
  v_cmp_lt_u32 vcc, v60, v62
  v_add_u32 v63, v66, v60
  v_add_u32 v60, v62, v77
  v_cndmask_b32 v117, 0, v63, vcc
  s_mov_b64 exec, vcc
  buffer_load_ushort v25, v117, s[8:11], 0 idxen
  buffer_load_dword v117, v117, s[4:7], 0 idxen
  s_mov_b64 exec, -1
  v_mul_hi_u32_u24 v62, 0xe000, v58
  v_cmp_lt_u32 vcc, v60, v62
  v_add_u32 v63, v66, v60
  v_add_u32 v60, v62, v77
  v_cndmask_b32 v121, 0, v63, vcc
  s_mov_b64 exec, vcc
  buffer_load_ushort v93, v121, s[8:11], 0 idxen
  buffer_load_dword v121, v121, s[4:7], 0 idxen
  s_mov_b64 exec, -1
  v_mul_hi_u32_u24 v62, 0x10000, v58
  v_cmp_lt_u32 vcc, v60, v62
  v_add_u32 v63, v66, v60
  v_add_u32 v60, v62, v77
  v_cndmask_b32 v125, 0, v63, vcc
  s_mov_b64 exec, vcc
  buffer_load_ushort v29, v125, s[8:11], 0 idxen
  buffer_load_dword v125, v125, s[4:7], 0 idxen
  s_mov_b64 exec, -1
  v_cmp_lt_u32 vcc, v64, v70
  v_add_u32 v63, v66, v64
  s_nop 0
  v_cndmask_b32 v74, 0, v63, vcc
  v_min_u32 v58, 0x80, v71
  v_mov_b32 v60, v77
  v_lshlrev_b32 v58, 16, v58
  v_mul_hi_u32_u24 v62, 0x2000, v58
  v_cmp_lt_u32 vcc, v60, v62
  v_add_u32 v63, v67, v60
  v_add_u32 v60, v62, v77
  v_cndmask_b32 v98, 0, v63, vcc
  s_mov_b64 exec, vcc
  buffer_load_ushort v82, v98, s[8:11], 0 idxen
  buffer_load_dword v98, v98, s[4:7], 0 idxen
  s_mov_b64 exec, -1
  v_mul_hi_u32_u24 v62, 0x4000, v58
  v_cmp_lt_u32 vcc, v60, v62
  v_add_u32 v63, v67, v60
  v_add_u32 v60, v62, v77
  v_cndmask_b32 v102, 0, v63, vcc
  s_mov_b64 exec, vcc
  buffer_load_ushort v18, v102, s[8:11], 0 idxen
  buffer_load_dword v102, v102, s[4:7], 0 idxen
  s_mov_b64 exec, -1
  v_mul_hi_u32_u24 v62, 0x6000, v58
  v_cmp_lt_u32 vcc, v60, v62
  v_add_u32 v63, v67, v60
  v_add_u32 v60, v62, v77
  v_cndmask_b32 v106, 0, v63, vcc
  s_mov_b64 exec, vcc
  buffer_load_ushort v86, v106, s[8:11], 0 idxen
  buffer_load_dword v106, v106, s[4:7], 0 idxen
  s_mov_b64 exec, -1
  v_mul_hi_u32_u24 v62, 0x8000, v58
  v_cmp_lt_u32 vcc, v60, v62
  v_add_u32 v63, v67, v60
  v_add_u32 v60, v62, v77
  v_cndmask_b32 v110, 0, v63, vcc
  s_mov_b64 exec, vcc
  buffer_load_ushort v22, v110, s[8:11], 0 idxen
  buffer_load_dword v110, v110, s[4:7], 0 idxen
  s_mov_b64 exec, -1
  v_mul_hi_u32_u24 v62, 0xa000, v58
  v_cmp_lt_u32 vcc, v60, v62
  v_add_u32 v63, v67, v60
  v_add_u32 v60, v62, v77
  v_cndmask_b32 v114, 0, v63, vcc
  s_mov_b64 exec, vcc
  buffer_load_ushort v90, v114, s[8:11], 0 idxen
  buffer_load_dword v114, v114, s[4:7], 0 idxen
  s_mov_b64 exec, -1
  v_mul_hi_u32_u24 v62, 0xc000, v58
  v_cmp_lt_u32 vcc, v60, v62
  v_add_u32 v63, v67, v60
  v_add_u32 v60, v62, v77
  v_cndmask_b32 v118, 0, v63, vcc
  s_mov_b64 exec, vcc
  buffer_load_ushort v26, v118, s[8:11], 0 idxen
  buffer_load_dword v118, v118, s[4:7], 0 idxen
  s_mov_b64 exec, -1
  v_mul_hi_u32_u24 v62, 0xe000, v58
  v_cmp_lt_u32 vcc, v60, v62
  v_add_u32 v63, v67, v60
  v_add_u32 v60, v62, v77
  v_cndmask_b32 v122, 0, v63, vcc
  s_mov_b64 exec, vcc
  buffer_load_ushort v94, v122, s[8:11], 0 idxen
  buffer_load_dword v122, v122, s[4:7], 0 idxen
  s_mov_b64 exec, -1
  v_mul_hi_u32_u24 v62, 0x10000, v58
  v_cmp_lt_u32 vcc, v60, v62
  v_add_u32 v63, v67, v60
  v_add_u32 v60, v62, v77
  v_cndmask_b32 v126, 0, v63, vcc
  s_mov_b64 exec, vcc
  buffer_load_ushort v30, v126, s[8:11], 0 idxen
  buffer_load_dword v126, v126, s[4:7], 0 idxen
  s_mov_b64 exec, -1
  v_cmp_lt_u32 vcc, v64, v71
  v_add_u32 v63, v67, v64
  s_nop 0
  v_cndmask_b32 v75, 0, v63, vcc
  s_waitcnt vmcnt(32)
  v_min_u32 v58, 0x80, v72
  v_mov_b32 v60, v77
  v_lshlrev_b32 v58, 16, v58
  v_mul_hi_u32_u24 v62, 0x2000, v58
  v_cmp_lt_u32 vcc, v60, v62
  v_add_u32 v63, v68, v60
  v_add_u32 v60, v62, v77
  v_cndmask_b32 v99, 0, v63, vcc
  s_mov_b64 exec, vcc
  buffer_load_ushort v83, v99, s[8:11], 0 idxen
  buffer_load_dword v99, v99, s[4:7], 0 idxen
  s_mov_b64 exec, -1
  v_mul_hi_u32_u24 v62, 0x4000, v58
  v_cmp_lt_u32 vcc, v60, v62
  v_add_u32 v63, v68, v60
  v_add_u32 v60, v62, v77
  v_cndmask_b32 v103, 0, v63, vcc
  s_mov_b64 exec, vcc
  buffer_load_ushort v19, v103, s[8:11], 0 idxen
  buffer_load_dword v103, v103, s[4:7], 0 idxen
  s_mov_b64 exec, -1
  v_mul_hi_u32_u24 v62, 0x6000, v58
  v_cmp_lt_u32 vcc, v60, v62
  v_add_u32 v63, v68, v60
  v_add_u32 v60, v62, v77
  v_cndmask_b32 v107, 0, v63, vcc
  s_mov_b64 exec, vcc
  buffer_load_ushort v87, v107, s[8:11], 0 idxen
  buffer_load_dword v107, v107, s[4:7], 0 idxen
  s_mov_b64 exec, -1
  v_mul_hi_u32_u24 v62, 0x8000, v58
  v_cmp_lt_u32 vcc, v60, v62
  v_add_u32 v63, v68, v60
  v_add_u32 v60, v62, v77
  v_cndmask_b32 v111, 0, v63, vcc
  s_mov_b64 exec, vcc
  buffer_load_ushort v23, v111, s[8:11], 0 idxen
  buffer_load_dword v111, v111, s[4:7], 0 idxen
  s_mov_b64 exec, -1
  v_mul_hi_u32_u24 v62, 0xa000, v58
  v_cmp_lt_u32 vcc, v60, v62
  v_add_u32 v63, v68, v60
  v_add_u32 v60, v62, v77
  v_cndmask_b32 v115, 0, v63, vcc
  s_mov_b64 exec, vcc
  buffer_load_ushort v91, v115, s[8:11], 0 idxen
  buffer_load_dword v115, v115, s[4:7], 0 idxen
  s_mov_b64 exec, -1
  v_mul_hi_u32_u24 v62, 0xc000, v58
  v_cmp_lt_u32 vcc, v60, v62
  v_add_u32 v63, v68, v60
  v_add_u32 v60, v62, v77
  v_cndmask_b32 v119, 0, v63, vcc
  s_mov_b64 exec, vcc
  buffer_load_ushort v27, v119, s[8:11], 0 idxen
  buffer_load_dword v119, v119, s[4:7], 0 idxen
  s_mov_b64 exec, -1
  v_mul_hi_u32_u24 v62, 0xe000, v58
  v_cmp_lt_u32 vcc, v60, v62
  v_add_u32 v63, v68, v60
  v_add_u32 v60, v62, v77
  v_cndmask_b32 v123, 0, v63, vcc
  s_mov_b64 exec, vcc
  buffer_load_ushort v95, v123, s[8:11], 0 idxen
  buffer_load_dword v123, v123, s[4:7], 0 idxen
  s_mov_b64 exec, -1
  v_mul_hi_u32_u24 v62, 0x10000, v58
  v_cmp_lt_u32 vcc, v60, v62
  v_add_u32 v63, v68, v60
  v_add_u32 v60, v62, v77
  v_cndmask_b32 v127, 0, v63, vcc
  s_mov_b64 exec, vcc
  buffer_load_ushort v31, v127, s[8:11], 0 idxen
  buffer_load_dword v127, v127, s[4:7], 0 idxen
  s_mov_b64 exec, -1
  v_cmp_lt_u32 vcc, v64, v72
  v_add_u32 v63, v68, v64
  s_nop 0
  v_cndmask_b32 v76, 0, v63, vcc
  s_setprio 0
  v_max3_u32 v48, v48, v50, v52
  v_max3_u32 v49, v49, v51, v53
  v_max_u32 v48, v48, v54
  v_max_u32 v49, v49, v55
  s_nop 1
  v_max_u32_dpp v48, v48, v48 row_shr:1 row_mask:0xf bank_mask:0xf
  v_max_u32_dpp v49, v49, v49 row_shr:1 row_mask:0xf bank_mask:0xf
  s_nop 1
  v_max_u32_dpp v48, v48, v48 row_shr:2 row_mask:0xf bank_mask:0xf
  v_max_u32_dpp v49, v49, v49 row_shr:2 row_mask:0xf bank_mask:0xf
  s_nop 1
  v_max_u32_dpp v48, v48, v48 row_shr:4 row_mask:0xf bank_mask:0xf
  v_max_u32_dpp v49, v49, v49 row_shr:4 row_mask:0xf bank_mask:0xf
  s_nop 1
  v_max_u32_dpp v48, v48, v48 row_shr:8 row_mask:0xf bank_mask:0xf
  v_max_u32_dpp v49, v49, v49 row_shr:8 row_mask:0xf bank_mask:0xf
  s_nop 1
  v_max_u32_dpp v48, v48, v48 row_bcast:15 row_mask:0xa bank_mask:0xf
  v_max_u32_dpp v49, v49, v49 row_bcast:15 row_mask:0xa bank_mask:0xf
  s_nop 1
  v_max_u32_dpp v48, v48, v48 row_bcast:31 row_mask:0xc bank_mask:0xf
  v_max_u32_dpp v49, v49, v49 row_bcast:31 row_mask:0xc bank_mask:0xf
  s_nop 0
  v_readlane_b32 s80, v48, 63
  v_readlane_b32 s81, v49, 63
  s_nop 0
  s_lshr_b32 s82, s80, 7
  s_sub_u32 s81, 0x8000, s81
  s_lshr_b32 s81, s81, 7
  s_sub_u32 s83, s82, s81
  s_cmp_eq_u32 s56, 2
  s_cbranch_scc1 LB_float
  s_cmp_ge_u32 s80, 0x7f80
  s_cbranch_scc1 LB_float
  s_cmp_lt_u32 s82, 32
  s_cbranch_scc1 LB_float
  s_cmp_gt_u32 s82, 200
  s_cbranch_scc1 LB_float
  s_cmp_gt_i32 s83, 10
  s_cbranch_scc1 LB_float
  s_mov_b32 s53, 0x4b400000
  s_sub_u32 s83, 275, s82
  s_lshl_b32 s54, s83, 23
  s_sub_u32 s83, s82, 21
  s_lshl_b32 s55, s83, 23
  s_branch LB_fast
LB_float:
  s_mov_b32 s56, 2
  s_mov_b32 s53, 0
  s_mov_b32 s54, 1.0
  s_mov_b32 s55, 1.0
  s_mov_b32 s59, 1
  s_waitcnt vmcnt(0) lgkmcnt(0)
  s_barrier
  s_branch LB_generic
LB_fast:
  v_perm_b32 v80, v16, v80, s60
  v_perm_b32 v84, v20, v84, s60
  v_perm_b32 v88, v24, v88, s60
  v_perm_b32 v92, v28, v92, s60
  s_waitcnt vmcnt(45)
  v_perm_b32 v81, v17, v81, s60
  s_waitcnt vmcnt(41)
  v_perm_b32 v85, v21, v85, s60
  s_waitcnt vmcnt(37)
  v_perm_b32 v89, v25, v89, s60
  s_waitcnt vmcnt(33)
  v_perm_b32 v93, v29, v93, s60
  s_waitcnt vmcnt(29)
  v_perm_b32 v82, v18, v82, s60
  s_waitcnt vmcnt(25)
  v_perm_b32 v86, v22, v86, s60
  s_waitcnt vmcnt(21)
  v_perm_b32 v90, v26, v90, s60
  s_waitcnt vmcnt(17)
  v_perm_b32 v94, v30, v94, s60
  s_waitcnt vmcnt(13)
  v_perm_b32 v83, v19, v83, s60
  s_waitcnt vmcnt(9)
  v_perm_b32 v87, v23, v87, s60
  s_waitcnt vmcnt(5)
  v_perm_b32 v91, v27, v91, s60
  s_waitcnt vmcnt(1)
  v_perm_b32 v95, v31, v95, s60
  s_waitcnt vmcnt(0)
  s_waitcnt lgkmcnt(0)
  s_barrier
  v_bfi_b32 v62, v96, 0, s57
  v_bfe_u32 v63, v96, 19, 11
  v_lshlrev_b32 v64, 16, v80
  v_mad_i32_i24 v40, v63, s58, v6
  v_mul_f32 v44, s54, v64
  ds_add_u32 v40, v7 offset:64
  v_mov_b32_dpp v2, v62 quad_perm:[0,0,2,2] row_mask:0xf bank_mask:0xf
  buffer_load_dwordx4 v[8:11], v[2:3], s[12:15], 0 idxen offen
  v_mov_b32_dpp v4, v62 quad_perm:[1,1,3,3] row_mask:0xf bank_mask:0xf
  buffer_load_dwordx4 v[12:15], v[4:5], s[12:15], 0 idxen offen
  v_bfi_b32 v62, v97, 0, s57
  v_bfe_u32 v63, v97, 19, 11
  v_lshlrev_b32 v64, 16, v81
  v_mad_i32_i24 v41, v63, s58, v6
  v_mul_f32 v45, s54, v64
  ds_add_u32 v41, v7 offset:64
  v_mov_b32_dpp v2, v62 quad_perm:[0,0,2,2] row_mask:0xf bank_mask:0xf
  buffer_load_dwordx4 v[16:19], v[2:3], s[12:15], 0 idxen offen
  v_mov_b32_dpp v4, v62 quad_perm:[1,1,3,3] row_mask:0xf bank_mask:0xf
  buffer_load_dwordx4 v[20:23], v[4:5], s[12:15], 0 idxen offen
  v_bfi_b32 v62, v98, 0, s57
  v_bfe_u32 v63, v98, 19, 11
  v_lshlrev_b32 v64, 16, v82
  v_mad_i32_i24 v42, v63, s58, v6
  v_mul_f32 v46, s54, v64
  ds_add_u32 v42, v7 offset:64
  v_mov_b32_dpp v2, v62 quad_perm:[0,0,2,2] row_mask:0xf bank_mask:0xf
  buffer_load_dwordx4 v[24:27], v[2:3], s[12:15], 0 idxen offen
  v_mov_b32_dpp v4, v62 quad_perm:[1,1,3,3] row_mask:0xf bank_mask:0xf
  buffer_load_dwordx4 v[28:31], v[4:5], s[12:15], 0 idxen offen
  v_bfi_b32 v62, v99, 0, s57
  v_bfe_u32 v63, v99, 19, 11
  v_lshlrev_b32 v64, 16, v83
  v_mad_i32_i24 v43, v63, s58, v6
  v_mul_f32 v47, s54, v64
  ds_add_u32 v43, v7 offset:64
  v_mov_b32_dpp v2, v62 quad_perm:[0,0,2,2] row_mask:0xf bank_mask:0xf
  buffer_load_dwordx4 v[32:35], v[2:3], s[12:15], 0 idxen offen
  v_mov_b32_dpp v4, v62 quad_perm:[1,1,3,3] row_mask:0xf bank_mask:0xf
  buffer_load_dwordx4 v[36:39], v[4:5], s[12:15], 0 idxen offen
  s_barrier
  v_bfi_b32 v62, v100, 0, s57
  s_waitcnt vmcnt(7)
  v_mov_b32_dpp v57, v44 quad_perm:[0,0,2,2] row_mask:0xf bank_mask:0xf
  v_add_u32_dpp v56, v40, v1 quad_perm:[0,0,2,2] row_mask:0xf bank_mask:0xf
  v_lshrrev_b32 v58, 16, v57
  v_dot2_f32_bf16 v49, v8, v57, s53
  v_dot2_f32_bf16 v48, v8, v58, s53
  ds_add_u64 v56, v[48:49] offset:0
  v_dot2_f32_bf16 v51, v9, v57, s53
  v_dot2_f32_bf16 v50, v9, v58, s53
  ds_add_u64 v56, v[50:51] offset:16
  v_dot2_f32_bf16 v53, v10, v57, s53
  v_dot2_f32_bf16 v52, v10, v58, s53
  ds_add_u64 v56, v[52:53] offset:32
  v_dot2_f32_bf16 v55, v11, v57, s53
  v_dot2_f32_bf16 v54, v11, v58, s53
  ds_add_u64 v56, v[54:55] offset:48
  v_mov_b32_dpp v2, v62 quad_perm:[0,0,2,2] row_mask:0xf bank_mask:0xf
  buffer_load_dwordx4 v[8:11], v[2:3], s[12:15], 0 idxen offen
  s_waitcnt vmcnt(7)
  v_mov_b32_dpp v60, v44 quad_perm:[1,1,3,3] row_mask:0xf bank_mask:0xf
  v_add_u32_dpp v59, v40, v1 quad_perm:[1,1,3,3] row_mask:0xf bank_mask:0xf
  v_lshrrev_b32 v61, 16, v60
  v_dot2_f32_bf16 v49, v12, v60, s53
  v_dot2_f32_bf16 v48, v12, v61, s53
  ds_add_u64 v59, v[48:49] offset:0
  v_dot2_f32_bf16 v51, v13, v60, s53
  v_dot2_f32_bf16 v50, v13, v61, s53
  ds_add_u64 v59, v[50:51] offset:16
  v_dot2_f32_bf16 v53, v14, v60, s53
  v_dot2_f32_bf16 v52, v14, v61, s53
  ds_add_u64 v59, v[52:53] offset:32
  v_dot2_f32_bf16 v55, v15, v60, s53
  v_dot2_f32_bf16 v54, v15, v61, s53
  ds_add_u64 v59, v[54:55] offset:48
  v_mov_b32_dpp v4, v62 quad_perm:[1,1,3,3] row_mask:0xf bank_mask:0xf
  buffer_load_dwordx4 v[12:15], v[4:5], s[12:15], 0 idxen offen
  v_bfe_u32 v63, v100, 19, 11
  v_and_b32 v64, 0xffff0000, v80
  v_mad_i32_i24 v40, v63, s58, v6
  v_mul_f32 v44, s54, v64
  ds_add_u32 v40, v7 offset:64
  v_bfi_b32 v62, v101, 0, s57
  s_waitcnt vmcnt(7)
  v_mov_b32_dpp v57, v45 quad_perm:[0,0,2,2] row_mask:0xf bank_mask:0xf
  v_add_u32_dpp v56, v41, v1 quad_perm:[0,0,2,2] row_mask:0xf bank_mask:0xf
  v_lshrrev_b32 v58, 16, v57
  v_dot2_f32_bf16 v49, v16, v57, s53
  v_dot2_f32_bf16 v48, v16, v58, s53
  ds_add_u64 v56, v[48:49] offset:0
  v_dot2_f32_bf16 v51, v17, v57, s53
  v_dot2_f32_bf16 v50, v17, v58, s53
  ds_add_u64 v56, v[50:51] offset:16
  v_dot2_f32_bf16 v53, v18, v57, s53
  v_dot2_f32_bf16 v52, v18, v58, s53
  ds_add_u64 v56, v[52:53] offset:32
  v_dot2_f32_bf16 v55, v19, v57, s53
  v_dot2_f32_bf16 v54, v19, v58, s53
  ds_add_u64 v56, v[54:55] offset:48
  v_mov_b32_dpp v2, v62 quad_perm:[0,0,2,2] row_mask:0xf bank_mask:0xf
  buffer_load_dwordx4 v[16:19], v[2:3], s[12:15], 0 idxen offen
  s_waitcnt vmcnt(7)
  v_mov_b32_dpp v60, v45 quad_perm:[1,1,3,3] row_mask:0xf bank_mask:0xf
  v_add_u32_dpp v59, v41, v1 quad_perm:[1,1,3,3] row_mask:0xf bank_mask:0xf
  v_lshrrev_b32 v61, 16, v60
  v_dot2_f32_bf16 v49, v20, v60, s53
  v_dot2_f32_bf16 v48, v20, v61, s53
  ds_add_u64 v59, v[48:49] offset:0
  v_dot2_f32_bf16 v51, v21, v60, s53
  v_dot2_f32_bf16 v50, v21, v61, s53
  ds_add_u64 v59, v[50:51] offset:16
  v_dot2_f32_bf16 v53, v22, v60, s53
  v_dot2_f32_bf16 v52, v22, v61, s53
  ds_add_u64 v59, v[52:53] offset:32
  v_dot2_f32_bf16 v55, v23, v60, s53
  v_dot2_f32_bf16 v54, v23, v61, s53
  ds_add_u64 v59, v[54:55] offset:48
  v_mov_b32_dpp v4, v62 quad_perm:[1,1,3,3] row_mask:0xf bank_mask:0xf
  buffer_load_dwordx4 v[20:23], v[4:5], s[12:15], 0 idxen offen
  v_bfe_u32 v63, v101, 19, 11
  v_and_b32 v64, 0xffff0000, v81
  v_mad_i32_i24 v41, v63, s58, v6
  v_mul_f32 v45, s54, v64
  ds_add_u32 v41, v7 offset:64
  v_bfi_b32 v62, v102, 0, s57
  s_waitcnt vmcnt(7)
  v_mov_b32_dpp v57, v46 quad_perm:[0,0,2,2] row_mask:0xf bank_mask:0xf
  v_add_u32_dpp v56, v42, v1 quad_perm:[0,0,2,2] row_mask:0xf bank_mask:0xf
  v_lshrrev_b32 v58, 16, v57
  v_dot2_f32_bf16 v49, v24, v57, s53
  v_dot2_f32_bf16 v48, v24, v58, s53
  ds_add_u64 v56, v[48:49] offset:0
  v_dot2_f32_bf16 v51, v25, v57, s53
  v_dot2_f32_bf16 v50, v25, v58, s53
  ds_add_u64 v56, v[50:51] offset:16
  v_dot2_f32_bf16 v53, v26, v57, s53
  v_dot2_f32_bf16 v52, v26, v58, s53
  ds_add_u64 v56, v[52:53] offset:32
  v_dot2_f32_bf16 v55, v27, v57, s53
  v_dot2_f32_bf16 v54, v27, v58, s53
  ds_add_u64 v56, v[54:55] offset:48
  v_mov_b32_dpp v2, v62 quad_perm:[0,0,2,2] row_mask:0xf bank_mask:0xf
  buffer_load_dwordx4 v[24:27], v[2:3], s[12:15], 0 idxen offen
  s_waitcnt vmcnt(7)
  v_mov_b32_dpp v60, v46 quad_perm:[1,1,3,3] row_mask:0xf bank_mask:0xf
  v_add_u32_dpp v59, v42, v1 quad_perm:[1,1,3,3] row_mask:0xf bank_mask:0xf
  v_lshrrev_b32 v61, 16, v60
  v_dot2_f32_bf16 v49, v28, v60, s53
  v_dot2_f32_bf16 v48, v28, v61, s53
  ds_add_u64 v59, v[48:49] offset:0
  v_dot2_f32_bf16 v51, v29, v60, s53
  v_dot2_f32_bf16 v50, v29, v61, s53
  ds_add_u64 v59, v[50:51] offset:16
  v_dot2_f32_bf16 v53, v30, v60, s53
  v_dot2_f32_bf16 v52, v30, v61, s53
  ds_add_u64 v59, v[52:53] offset:32
  v_dot2_f32_bf16 v55, v31, v60, s53
  v_dot2_f32_bf16 v54, v31, v61, s53
  ds_add_u64 v59, v[54:55] offset:48
  v_mov_b32_dpp v4, v62 quad_perm:[1,1,3,3] row_mask:0xf bank_mask:0xf
  buffer_load_dwordx4 v[28:31], v[4:5], s[12:15], 0 idxen offen
  v_bfe_u32 v63, v102, 19, 11
  v_and_b32 v64, 0xffff0000, v82
  v_mad_i32_i24 v42, v63, s58, v6
  v_mul_f32 v46, s54, v64
  ds_add_u32 v42, v7 offset:64
  v_bfi_b32 v62, v103, 0, s57
  s_waitcnt vmcnt(7)
  v_mov_b32_dpp v57, v47 quad_perm:[0,0,2,2] row_mask:0xf bank_mask:0xf
  v_add_u32_dpp v56, v43, v1 quad_perm:[0,0,2,2] row_mask:0xf bank_mask:0xf
  v_lshrrev_b32 v58, 16, v57
  v_dot2_f32_bf16 v49, v32, v57, s53
  v_dot2_f32_bf16 v48, v32, v58, s53
  ds_add_u64 v56, v[48:49] offset:0
  v_dot2_f32_bf16 v51, v33, v57, s53
  v_dot2_f32_bf16 v50, v33, v58, s53
  ds_add_u64 v56, v[50:51] offset:16
  v_dot2_f32_bf16 v53, v34, v57, s53
  v_dot2_f32_bf16 v52, v34, v58, s53
  ds_add_u64 v56, v[52:53] offset:32
  v_dot2_f32_bf16 v55, v35, v57, s53
  v_dot2_f32_bf16 v54, v35, v58, s53
  ds_add_u64 v56, v[54:55] offset:48
  v_mov_b32_dpp v2, v62 quad_perm:[0,0,2,2] row_mask:0xf bank_mask:0xf
  buffer_load_dwordx4 v[32:35], v[2:3], s[12:15], 0 idxen offen
  s_waitcnt vmcnt(7)
  v_mov_b32_dpp v60, v47 quad_perm:[1,1,3,3] row_mask:0xf bank_mask:0xf
  v_add_u32_dpp v59, v43, v1 quad_perm:[1,1,3,3] row_mask:0xf bank_mask:0xf
  v_lshrrev_b32 v61, 16, v60
  v_dot2_f32_bf16 v49, v36, v60, s53
  v_dot2_f32_bf16 v48, v36, v61, s53
  ds_add_u64 v59, v[48:49] offset:0
  v_dot2_f32_bf16 v51, v37, v60, s53
  v_dot2_f32_bf16 v50, v37, v61, s53
  ds_add_u64 v59, v[50:51] offset:16
  v_dot2_f32_bf16 v53, v38, v60, s53
  v_dot2_f32_bf16 v52, v38, v61, s53
  ds_add_u64 v59, v[52:53] offset:32
  v_dot2_f32_bf16 v55, v39, v60, s53
  v_dot2_f32_bf16 v54, v39, v61, s53
  ds_add_u64 v59, v[54:55] offset:48
  v_mov_b32_dpp v4, v62 quad_perm:[1,1,3,3] row_mask:0xf bank_mask:0xf
  buffer_load_dwordx4 v[36:39], v[4:5], s[12:15], 0 idxen offen
  v_bfe_u32 v63, v103, 19, 11
  v_and_b32 v64, 0xffff0000, v83
  v_mad_i32_i24 v43, v63, s58, v6
  v_mul_f32 v47, s54, v64
  ds_add_u32 v43, v7 offset:64
  s_barrier
  v_bfi_b32 v62, v104, 0, s57
  s_waitcnt vmcnt(7)
  v_mov_b32_dpp v57, v44 quad_perm:[0,0,2,2] row_mask:0xf bank_mask:0xf
  v_add_u32_dpp v56, v40, v1 quad_perm:[0,0,2,2] row_mask:0xf bank_mask:0xf
  v_lshrrev_b32 v58, 16, v57
  v_dot2_f32_bf16 v49, v8, v57, s53
  v_dot2_f32_bf16 v48, v8, v58, s53
  ds_add_u64 v56, v[48:49] offset:0
  v_dot2_f32_bf16 v51, v9, v57, s53
  v_dot2_f32_bf16 v50, v9, v58, s53
  ds_add_u64 v56, v[50:51] offset:16
  v_dot2_f32_bf16 v53, v10, v57, s53
  v_dot2_f32_bf16 v52, v10, v58, s53
  ds_add_u64 v56, v[52:53] offset:32
  v_dot2_f32_bf16 v55, v11, v57, s53
  v_dot2_f32_bf16 v54, v11, v58, s53
  ds_add_u64 v56, v[54:55] offset:48
  v_mov_b32_dpp v2, v62 quad_perm:[0,0,2,2] row_mask:0xf bank_mask:0xf
  buffer_load_dwordx4 v[8:11], v[2:3], s[12:15], 0 idxen offen
  s_waitcnt vmcnt(7)
  v_mov_b32_dpp v60, v44 quad_perm:[1,1,3,3] row_mask:0xf bank_mask:0xf
  v_add_u32_dpp v59, v40, v1 quad_perm:[1,1,3,3] row_mask:0xf bank_mask:0xf
  v_lshrrev_b32 v61, 16, v60
  v_dot2_f32_bf16 v49, v12, v60, s53
  v_dot2_f32_bf16 v48, v12, v61, s53
  ds_add_u64 v59, v[48:49] offset:0
  v_dot2_f32_bf16 v51, v13, v60, s53
  v_dot2_f32_bf16 v50, v13, v61, s53
  ds_add_u64 v59, v[50:51] offset:16
  v_dot2_f32_bf16 v53, v14, v60, s53
  v_dot2_f32_bf16 v52, v14, v61, s53
  ds_add_u64 v59, v[52:53] offset:32
  v_dot2_f32_bf16 v55, v15, v60, s53
  v_dot2_f32_bf16 v54, v15, v61, s53
  ds_add_u64 v59, v[54:55] offset:48
  v_mov_b32_dpp v4, v62 quad_perm:[1,1,3,3] row_mask:0xf bank_mask:0xf
  buffer_load_dwordx4 v[12:15], v[4:5], s[12:15], 0 idxen offen
  v_bfe_u32 v63, v104, 19, 11
  v_lshlrev_b32 v64, 16, v84
  v_mad_i32_i24 v40, v63, s58, v6
  v_mul_f32 v44, s54, v64
  ds_add_u32 v40, v7 offset:64
  v_bfi_b32 v62, v105, 0, s57
  s_waitcnt vmcnt(7)
  v_mov_b32_dpp v57, v45 quad_perm:[0,0,2,2] row_mask:0xf bank_mask:0xf
  v_add_u32_dpp v56, v41, v1 quad_perm:[0,0,2,2] row_mask:0xf bank_mask:0xf
  v_lshrrev_b32 v58, 16, v57
  v_dot2_f32_bf16 v49, v16, v57, s53
  v_dot2_f32_bf16 v48, v16, v58, s53
  ds_add_u64 v56, v[48:49] offset:0
  v_dot2_f32_bf16 v51, v17, v57, s53
  v_dot2_f32_bf16 v50, v17, v58, s53
  ds_add_u64 v56, v[50:51] offset:16
  v_dot2_f32_bf16 v53, v18, v57, s53
  v_dot2_f32_bf16 v52, v18, v58, s53
  ds_add_u64 v56, v[52:53] offset:32
  v_dot2_f32_bf16 v55, v19, v57, s53
  v_dot2_f32_bf16 v54, v19, v58, s53
  ds_add_u64 v56, v[54:55] offset:48
  v_mov_b32_dpp v2, v62 quad_perm:[0,0,2,2] row_mask:0xf bank_mask:0xf
  buffer_load_dwordx4 v[16:19], v[2:3], s[12:15], 0 idxen offen
  s_waitcnt vmcnt(7)
  v_mov_b32_dpp v60, v45 quad_perm:[1,1,3,3] row_mask:0xf bank_mask:0xf
  v_add_u32_dpp v59, v41, v1 quad_perm:[1,1,3,3] row_mask:0xf bank_mask:0xf
  v_lshrrev_b32 v61, 16, v60
  v_dot2_f32_bf16 v49, v20, v60, s53
  v_dot2_f32_bf16 v48, v20, v61, s53
  ds_add_u64 v59, v[48:49] offset:0
  v_dot2_f32_bf16 v51, v21, v60, s53
  v_dot2_f32_bf16 v50, v21, v61, s53
  ds_add_u64 v59, v[50:51] offset:16
  v_dot2_f32_bf16 v53, v22, v60, s53
  v_dot2_f32_bf16 v52, v22, v61, s53
  ds_add_u64 v59, v[52:53] offset:32
  v_dot2_f32_bf16 v55, v23, v60, s53
  v_dot2_f32_bf16 v54, v23, v61, s53
  ds_add_u64 v59, v[54:55] offset:48
  v_mov_b32_dpp v4, v62 quad_perm:[1,1,3,3] row_mask:0xf bank_mask:0xf
  buffer_load_dwordx4 v[20:23], v[4:5], s[12:15], 0 idxen offen
  v_bfe_u32 v63, v105, 19, 11
  v_lshlrev_b32 v64, 16, v85
  v_mad_i32_i24 v41, v63, s58, v6
  v_mul_f32 v45, s54, v64
  ds_add_u32 v41, v7 offset:64
  v_bfi_b32 v62, v106, 0, s57
  s_waitcnt vmcnt(7)
  v_mov_b32_dpp v57, v46 quad_perm:[0,0,2,2] row_mask:0xf bank_mask:0xf
  v_add_u32_dpp v56, v42, v1 quad_perm:[0,0,2,2] row_mask:0xf bank_mask:0xf
  v_lshrrev_b32 v58, 16, v57
  v_dot2_f32_bf16 v49, v24, v57, s53
  v_dot2_f32_bf16 v48, v24, v58, s53
  ds_add_u64 v56, v[48:49] offset:0
  v_dot2_f32_bf16 v51, v25, v57, s53
  v_dot2_f32_bf16 v50, v25, v58, s53
  ds_add_u64 v56, v[50:51] offset:16
  v_dot2_f32_bf16 v53, v26, v57, s53
  v_dot2_f32_bf16 v52, v26, v58, s53
  ds_add_u64 v56, v[52:53] offset:32
  v_dot2_f32_bf16 v55, v27, v57, s53
  v_dot2_f32_bf16 v54, v27, v58, s53
  ds_add_u64 v56, v[54:55] offset:48
  v_mov_b32_dpp v2, v62 quad_perm:[0,0,2,2] row_mask:0xf bank_mask:0xf
  buffer_load_dwordx4 v[24:27], v[2:3], s[12:15], 0 idxen offen
  s_waitcnt vmcnt(7)
  v_mov_b32_dpp v60, v46 quad_perm:[1,1,3,3] row_mask:0xf bank_mask:0xf
  v_add_u32_dpp v59, v42, v1 quad_perm:[1,1,3,3] row_mask:0xf bank_mask:0xf
  v_lshrrev_b32 v61, 16, v60
  v_dot2_f32_bf16 v49, v28, v60, s53
  v_dot2_f32_bf16 v48, v28, v61, s53
  ds_add_u64 v59, v[48:49] offset:0
  v_dot2_f32_bf16 v51, v29, v60, s53
  v_dot2_f32_bf16 v50, v29, v61, s53
  ds_add_u64 v59, v[50:51] offset:16
  v_dot2_f32_bf16 v53, v30, v60, s53
  v_dot2_f32_bf16 v52, v30, v61, s53
  ds_add_u64 v59, v[52:53] offset:32
  v_dot2_f32_bf16 v55, v31, v60, s53
  v_dot2_f32_bf16 v54, v31, v61, s53
  ds_add_u64 v59, v[54:55] offset:48
  v_mov_b32_dpp v4, v62 quad_perm:[1,1,3,3] row_mask:0xf bank_mask:0xf
  buffer_load_dwordx4 v[28:31], v[4:5], s[12:15], 0 idxen offen
  v_bfe_u32 v63, v106, 19, 11
  v_lshlrev_b32 v64, 16, v86
  v_mad_i32_i24 v42, v63, s58, v6
  v_mul_f32 v46, s54, v64
  ds_add_u32 v42, v7 offset:64
  v_bfi_b32 v62, v107, 0, s57
  s_waitcnt vmcnt(7)
  v_mov_b32_dpp v57, v47 quad_perm:[0,0,2,2] row_mask:0xf bank_mask:0xf
  v_add_u32_dpp v56, v43, v1 quad_perm:[0,0,2,2] row_mask:0xf bank_mask:0xf
  v_lshrrev_b32 v58, 16, v57
  v_dot2_f32_bf16 v49, v32, v57, s53
  v_dot2_f32_bf16 v48, v32, v58, s53
  ds_add_u64 v56, v[48:49] offset:0
  v_dot2_f32_bf16 v51, v33, v57, s53
  v_dot2_f32_bf16 v50, v33, v58, s53
  ds_add_u64 v56, v[50:51] offset:16
  v_dot2_f32_bf16 v53, v34, v57, s53
  v_dot2_f32_bf16 v52, v34, v58, s53
  ds_add_u64 v56, v[52:53] offset:32
  v_dot2_f32_bf16 v55, v35, v57, s53
  v_dot2_f32_bf16 v54, v35, v58, s53
  ds_add_u64 v56, v[54:55] offset:48
  v_mov_b32_dpp v2, v62 quad_perm:[0,0,2,2] row_mask:0xf bank_mask:0xf
  buffer_load_dwordx4 v[32:35], v[2:3], s[12:15], 0 idxen offen
  s_waitcnt vmcnt(7)
  v_mov_b32_dpp v60, v47 quad_perm:[1,1,3,3] row_mask:0xf bank_mask:0xf
  v_add_u32_dpp v59, v43, v1 quad_perm:[1,1,3,3] row_mask:0xf bank_mask:0xf
  v_lshrrev_b32 v61, 16, v60
  v_dot2_f32_bf16 v49, v36, v60, s53
  v_dot2_f32_bf16 v48, v36, v61, s53
  ds_add_u64 v59, v[48:49] offset:0
  v_dot2_f32_bf16 v51, v37, v60, s53
  v_dot2_f32_bf16 v50, v37, v61, s53
  ds_add_u64 v59, v[50:51] offset:16
  v_dot2_f32_bf16 v53, v38, v60, s53
  v_dot2_f32_bf16 v52, v38, v61, s53
  ds_add_u64 v59, v[52:53] offset:32
  v_dot2_f32_bf16 v55, v39, v60, s53
  v_dot2_f32_bf16 v54, v39, v61, s53
  ds_add_u64 v59, v[54:55] offset:48
  v_mov_b32_dpp v4, v62 quad_perm:[1,1,3,3] row_mask:0xf bank_mask:0xf
  buffer_load_dwordx4 v[36:39], v[4:5], s[12:15], 0 idxen offen
  v_bfe_u32 v63, v107, 19, 11
  v_lshlrev_b32 v64, 16, v87
  v_mad_i32_i24 v43, v63, s58, v6
  v_mul_f32 v47, s54, v64
  ds_add_u32 v43, v7 offset:64
  s_barrier
  v_bfi_b32 v62, v108, 0, s57
  s_waitcnt vmcnt(7)
  v_mov_b32_dpp v57, v44 quad_perm:[0,0,2,2] row_mask:0xf bank_mask:0xf
  v_add_u32_dpp v56, v40, v1 quad_perm:[0,0,2,2] row_mask:0xf bank_mask:0xf
  v_lshrrev_b32 v58, 16, v57
  v_dot2_f32_bf16 v49, v8, v57, s53
  v_dot2_f32_bf16 v48, v8, v58, s53
  ds_add_u64 v56, v[48:49] offset:0
  v_dot2_f32_bf16 v51, v9, v57, s53
  v_dot2_f32_bf16 v50, v9, v58, s53
  ds_add_u64 v56, v[50:51] offset:16
  v_dot2_f32_bf16 v53, v10, v57, s53
  v_dot2_f32_bf16 v52, v10, v58, s53
  ds_add_u64 v56, v[52:53] offset:32
  v_dot2_f32_bf16 v55, v11, v57, s53
  v_dot2_f32_bf16 v54, v11, v58, s53
  ds_add_u64 v56, v[54:55] offset:48
  v_mov_b32_dpp v2, v62 quad_perm:[0,0,2,2] row_mask:0xf bank_mask:0xf
  buffer_load_dwordx4 v[8:11], v[2:3], s[12:15], 0 idxen offen
  s_waitcnt vmcnt(7)
  v_mov_b32_dpp v60, v44 quad_perm:[1,1,3,3] row_mask:0xf bank_mask:0xf
  v_add_u32_dpp v59, v40, v1 quad_perm:[1,1,3,3] row_mask:0xf bank_mask:0xf
  v_lshrrev_b32 v61, 16, v60
  v_dot2_f32_bf16 v49, v12, v60, s53
  v_dot2_f32_bf16 v48, v12, v61, s53
  ds_add_u64 v59, v[48:49] offset:0
  v_dot2_f32_bf16 v51, v13, v60, s53
  v_dot2_f32_bf16 v50, v13, v61, s53
  ds_add_u64 v59, v[50:51] offset:16
  v_dot2_f32_bf16 v53, v14, v60, s53
  v_dot2_f32_bf16 v52, v14, v61, s53
  ds_add_u64 v59, v[52:53] offset:32
  v_dot2_f32_bf16 v55, v15, v60, s53
  v_dot2_f32_bf16 v54, v15, v61, s53
  ds_add_u64 v59, v[54:55] offset:48
  v_mov_b32_dpp v4, v62 quad_perm:[1,1,3,3] row_mask:0xf bank_mask:0xf
  buffer_load_dwordx4 v[12:15], v[4:5], s[12:15], 0 idxen offen
  v_bfe_u32 v63, v108, 19, 11
  v_and_b32 v64, 0xffff0000, v84
  v_mad_i32_i24 v40, v63, s58, v6
  v_mul_f32 v44, s54, v64
  ds_add_u32 v40, v7 offset:64
  v_bfi_b32 v62, v109, 0, s57
  s_waitcnt vmcnt(7)
  v_mov_b32_dpp v57, v45 quad_perm:[0,0,2,2] row_mask:0xf bank_mask:0xf
  v_add_u32_dpp v56, v41, v1 quad_perm:[0,0,2,2] row_mask:0xf bank_mask:0xf
  v_lshrrev_b32 v58, 16, v57
  v_dot2_f32_bf16 v49, v16, v57, s53
  v_dot2_f32_bf16 v48, v16, v58, s53
  ds_add_u64 v56, v[48:49] offset:0
  v_dot2_f32_bf16 v51, v17, v57, s53
  v_dot2_f32_bf16 v50, v17, v58, s53
  ds_add_u64 v56, v[50:51] offset:16
  v_dot2_f32_bf16 v53, v18, v57, s53
  v_dot2_f32_bf16 v52, v18, v58, s53
  ds_add_u64 v56, v[52:53] offset:32
  v_dot2_f32_bf16 v55, v19, v57, s53
  v_dot2_f32_bf16 v54, v19, v58, s53
  ds_add_u64 v56, v[54:55] offset:48
  v_mov_b32_dpp v2, v62 quad_perm:[0,0,2,2] row_mask:0xf bank_mask:0xf
  buffer_load_dwordx4 v[16:19], v[2:3], s[12:15], 0 idxen offen
  s_waitcnt vmcnt(7)
  v_mov_b32_dpp v60, v45 quad_perm:[1,1,3,3] row_mask:0xf bank_mask:0xf
  v_add_u32_dpp v59, v41, v1 quad_perm:[1,1,3,3] row_mask:0xf bank_mask:0xf
  v_lshrrev_b32 v61, 16, v60
  v_dot2_f32_bf16 v49, v20, v60, s53
  v_dot2_f32_bf16 v48, v20, v61, s53
  ds_add_u64 v59, v[48:49] offset:0
  v_dot2_f32_bf16 v51, v21, v60, s53
  v_dot2_f32_bf16 v50, v21, v61, s53
  ds_add_u64 v59, v[50:51] offset:16
  v_dot2_f32_bf16 v53, v22, v60, s53
  v_dot2_f32_bf16 v52, v22, v61, s53
  ds_add_u64 v59, v[52:53] offset:32
  v_dot2_f32_bf16 v55, v23, v60, s53
  v_dot2_f32_bf16 v54, v23, v61, s53
  ds_add_u64 v59, v[54:55] offset:48
  v_mov_b32_dpp v4, v62 quad_perm:[1,1,3,3] row_mask:0xf bank_mask:0xf
  buffer_load_dwordx4 v[20:23], v[4:5], s[12:15], 0 idxen offen
  v_bfe_u32 v63, v109, 19, 11
  v_and_b32 v64, 0xffff0000, v85
  v_mad_i32_i24 v41, v63, s58, v6
  v_mul_f32 v45, s54, v64
  ds_add_u32 v41, v7 offset:64
  v_bfi_b32 v62, v110, 0, s57
  s_waitcnt vmcnt(7)
  v_mov_b32_dpp v57, v46 quad_perm:[0,0,2,2] row_mask:0xf bank_mask:0xf
  v_add_u32_dpp v56, v42, v1 quad_perm:[0,0,2,2] row_mask:0xf bank_mask:0xf
  v_lshrrev_b32 v58, 16, v57
  v_dot2_f32_bf16 v49, v24, v57, s53
  v_dot2_f32_bf16 v48, v24, v58, s53
  ds_add_u64 v56, v[48:49] offset:0
  v_dot2_f32_bf16 v51, v25, v57, s53
  v_dot2_f32_bf16 v50, v25, v58, s53
  ds_add_u64 v56, v[50:51] offset:16
  v_dot2_f32_bf16 v53, v26, v57, s53
  v_dot2_f32_bf16 v52, v26, v58, s53
  ds_add_u64 v56, v[52:53] offset:32
  v_dot2_f32_bf16 v55, v27, v57, s53
  v_dot2_f32_bf16 v54, v27, v58, s53
  ds_add_u64 v56, v[54:55] offset:48
  v_mov_b32_dpp v2, v62 quad_perm:[0,0,2,2] row_mask:0xf bank_mask:0xf
  buffer_load_dwordx4 v[24:27], v[2:3], s[12:15], 0 idxen offen
  s_waitcnt vmcnt(7)
  v_mov_b32_dpp v60, v46 quad_perm:[1,1,3,3] row_mask:0xf bank_mask:0xf
  v_add_u32_dpp v59, v42, v1 quad_perm:[1,1,3,3] row_mask:0xf bank_mask:0xf
  v_lshrrev_b32 v61, 16, v60
  v_dot2_f32_bf16 v49, v28, v60, s53
  v_dot2_f32_bf16 v48, v28, v61, s53
  ds_add_u64 v59, v[48:49] offset:0
  v_dot2_f32_bf16 v51, v29, v60, s53
  v_dot2_f32_bf16 v50, v29, v61, s53
  ds_add_u64 v59, v[50:51] offset:16
  v_dot2_f32_bf16 v53, v30, v60, s53
  v_dot2_f32_bf16 v52, v30, v61, s53
  ds_add_u64 v59, v[52:53] offset:32
  v_dot2_f32_bf16 v55, v31, v60, s53
  v_dot2_f32_bf16 v54, v31, v61, s53
  ds_add_u64 v59, v[54:55] offset:48
  v_mov_b32_dpp v4, v62 quad_perm:[1,1,3,3] row_mask:0xf bank_mask:0xf
  buffer_load_dwordx4 v[28:31], v[4:5], s[12:15], 0 idxen offen
  v_bfe_u32 v63, v110, 19, 11
  v_and_b32 v64, 0xffff0000, v86
  v_mad_i32_i24 v42, v63, s58, v6
  v_mul_f32 v46, s54, v64
  ds_add_u32 v42, v7 offset:64
  v_bfi_b32 v62, v111, 0, s57
  s_waitcnt vmcnt(7)
  v_mov_b32_dpp v57, v47 quad_perm:[0,0,2,2] row_mask:0xf bank_mask:0xf
  v_add_u32_dpp v56, v43, v1 quad_perm:[0,0,2,2] row_mask:0xf bank_mask:0xf
  v_lshrrev_b32 v58, 16, v57
  v_dot2_f32_bf16 v49, v32, v57, s53
  v_dot2_f32_bf16 v48, v32, v58, s53
  ds_add_u64 v56, v[48:49] offset:0
  v_dot2_f32_bf16 v51, v33, v57, s53
  v_dot2_f32_bf16 v50, v33, v58, s53
  ds_add_u64 v56, v[50:51] offset:16
  v_dot2_f32_bf16 v53, v34, v57, s53
  v_dot2_f32_bf16 v52, v34, v58, s53
  ds_add_u64 v56, v[52:53] offset:32
  v_dot2_f32_bf16 v55, v35, v57, s53
  v_dot2_f32_bf16 v54, v35, v58, s53
  ds_add_u64 v56, v[54:55] offset:48
  v_mov_b32_dpp v2, v62 quad_perm:[0,0,2,2] row_mask:0xf bank_mask:0xf
  buffer_load_dwordx4 v[32:35], v[2:3], s[12:15], 0 idxen offen
  s_waitcnt vmcnt(7)
  v_mov_b32_dpp v60, v47 quad_perm:[1,1,3,3] row_mask:0xf bank_mask:0xf
  v_add_u32_dpp v59, v43, v1 quad_perm:[1,1,3,3] row_mask:0xf bank_mask:0xf
  v_lshrrev_b32 v61, 16, v60
  v_dot2_f32_bf16 v49, v36, v60, s53
  v_dot2_f32_bf16 v48, v36, v61, s53
  ds_add_u64 v59, v[48:49] offset:0
  v_dot2_f32_bf16 v51, v37, v60, s53
  v_dot2_f32_bf16 v50, v37, v61, s53
  ds_add_u64 v59, v[50:51] offset:16
  v_dot2_f32_bf16 v53, v38, v60, s53
  v_dot2_f32_bf16 v52, v38, v61, s53
  ds_add_u64 v59, v[52:53] offset:32
  v_dot2_f32_bf16 v55, v39, v60, s53
  v_dot2_f32_bf16 v54, v39, v61, s53
  ds_add_u64 v59, v[54:55] offset:48
  v_mov_b32_dpp v4, v62 quad_perm:[1,1,3,3] row_mask:0xf bank_mask:0xf
  buffer_load_dwordx4 v[36:39], v[4:5], s[12:15], 0 idxen offen
  v_bfe_u32 v63, v111, 19, 11
  v_and_b32 v64, 0xffff0000, v87
  v_mad_i32_i24 v43, v63, s58, v6
  v_mul_f32 v47, s54, v64
  ds_add_u32 v43, v7 offset:64
  s_barrier
  v_bfi_b32 v62, v112, 0, s57
  s_waitcnt vmcnt(7)
  v_mov_b32_dpp v57, v44 quad_perm:[0,0,2,2] row_mask:0xf bank_mask:0xf
  v_add_u32_dpp v56, v40, v1 quad_perm:[0,0,2,2] row_mask:0xf bank_mask:0xf
  v_lshrrev_b32 v58, 16, v57
  v_dot2_f32_bf16 v49, v8, v57, s53
  v_dot2_f32_bf16 v48, v8, v58, s53
  ds_add_u64 v56, v[48:49] offset:0
  v_dot2_f32_bf16 v51, v9, v57, s53
  v_dot2_f32_bf16 v50, v9, v58, s53
  ds_add_u64 v56, v[50:51] offset:16
  v_dot2_f32_bf16 v53, v10, v57, s53
  v_dot2_f32_bf16 v52, v10, v58, s53
  ds_add_u64 v56, v[52:53] offset:32
  v_dot2_f32_bf16 v55, v11, v57, s53
  v_dot2_f32_bf16 v54, v11, v58, s53
  ds_add_u64 v56, v[54:55] offset:48
  v_mov_b32_dpp v2, v62 quad_perm:[0,0,2,2] row_mask:0xf bank_mask:0xf
  buffer_load_dwordx4 v[8:11], v[2:3], s[12:15], 0 idxen offen
  s_waitcnt vmcnt(7)
  v_mov_b32_dpp v60, v44 quad_perm:[1,1,3,3] row_mask:0xf bank_mask:0xf
  v_add_u32_dpp v59, v40, v1 quad_perm:[1,1,3,3] row_mask:0xf bank_mask:0xf
  v_lshrrev_b32 v61, 16, v60
  v_dot2_f32_bf16 v49, v12, v60, s53
  v_dot2_f32_bf16 v48, v12, v61, s53
  ds_add_u64 v59, v[48:49] offset:0
  v_dot2_f32_bf16 v51, v13, v60, s53
  v_dot2_f32_bf16 v50, v13, v61, s53
  ds_add_u64 v59, v[50:51] offset:16
  v_dot2_f32_bf16 v53, v14, v60, s53
  v_dot2_f32_bf16 v52, v14, v61, s53
  ds_add_u64 v59, v[52:53] offset:32
  v_dot2_f32_bf16 v55, v15, v60, s53
  v_dot2_f32_bf16 v54, v15, v61, s53
  ds_add_u64 v59, v[54:55] offset:48
  v_mov_b32_dpp v4, v62 quad_perm:[1,1,3,3] row_mask:0xf bank_mask:0xf
  buffer_load_dwordx4 v[12:15], v[4:5], s[12:15], 0 idxen offen
  v_bfe_u32 v63, v112, 19, 11
  v_lshlrev_b32 v64, 16, v88
  v_mad_i32_i24 v40, v63, s58, v6
  v_mul_f32 v44, s54, v64
  ds_add_u32 v40, v7 offset:64
  v_bfi_b32 v62, v113, 0, s57
  s_waitcnt vmcnt(7)
  v_mov_b32_dpp v57, v45 quad_perm:[0,0,2,2] row_mask:0xf bank_mask:0xf
  v_add_u32_dpp v56, v41, v1 quad_perm:[0,0,2,2] row_mask:0xf bank_mask:0xf
  v_lshrrev_b32 v58, 16, v57
  v_dot2_f32_bf16 v49, v16, v57, s53
  v_dot2_f32_bf16 v48, v16, v58, s53
  ds_add_u64 v56, v[48:49] offset:0
  v_dot2_f32_bf16 v51, v17, v57, s53
  v_dot2_f32_bf16 v50, v17, v58, s53
  ds_add_u64 v56, v[50:51] offset:16
  v_dot2_f32_bf16 v53, v18, v57, s53
  v_dot2_f32_bf16 v52, v18, v58, s53
  ds_add_u64 v56, v[52:53] offset:32
  v_dot2_f32_bf16 v55, v19, v57, s53
  v_dot2_f32_bf16 v54, v19, v58, s53
  ds_add_u64 v56, v[54:55] offset:48
  v_mov_b32_dpp v2, v62 quad_perm:[0,0,2,2] row_mask:0xf bank_mask:0xf
  buffer_load_dwordx4 v[16:19], v[2:3], s[12:15], 0 idxen offen
  s_waitcnt vmcnt(7)
  v_mov_b32_dpp v60, v45 quad_perm:[1,1,3,3] row_mask:0xf bank_mask:0xf
  v_add_u32_dpp v59, v41, v1 quad_perm:[1,1,3,3] row_mask:0xf bank_mask:0xf
  v_lshrrev_b32 v61, 16, v60
  v_dot2_f32_bf16 v49, v20, v60, s53
  v_dot2_f32_bf16 v48, v20, v61, s53
  ds_add_u64 v59, v[48:49] offset:0
  v_dot2_f32_bf16 v51, v21, v60, s53
  v_dot2_f32_bf16 v50, v21, v61, s53
  ds_add_u64 v59, v[50:51] offset:16
  v_dot2_f32_bf16 v53, v22, v60, s53
  v_dot2_f32_bf16 v52, v22, v61, s53
  ds_add_u64 v59, v[52:53] offset:32
  v_dot2_f32_bf16 v55, v23, v60, s53
  v_dot2_f32_bf16 v54, v23, v61, s53
  ds_add_u64 v59, v[54:55] offset:48
  v_mov_b32_dpp v4, v62 quad_perm:[1,1,3,3] row_mask:0xf bank_mask:0xf
  buffer_load_dwordx4 v[20:23], v[4:5], s[12:15], 0 idxen offen
  v_bfe_u32 v63, v113, 19, 11
  v_lshlrev_b32 v64, 16, v89
  v_mad_i32_i24 v41, v63, s58, v6
  v_mul_f32 v45, s54, v64
  ds_add_u32 v41, v7 offset:64
  v_bfi_b32 v62, v114, 0, s57
  s_waitcnt vmcnt(7)
  v_mov_b32_dpp v57, v46 quad_perm:[0,0,2,2] row_mask:0xf bank_mask:0xf
  v_add_u32_dpp v56, v42, v1 quad_perm:[0,0,2,2] row_mask:0xf bank_mask:0xf
  v_lshrrev_b32 v58, 16, v57
  v_dot2_f32_bf16 v49, v24, v57, s53
  v_dot2_f32_bf16 v48, v24, v58, s53
  ds_add_u64 v56, v[48:49] offset:0
  v_dot2_f32_bf16 v51, v25, v57, s53
  v_dot2_f32_bf16 v50, v25, v58, s53
  ds_add_u64 v56, v[50:51] offset:16
  v_dot2_f32_bf16 v53, v26, v57, s53
  v_dot2_f32_bf16 v52, v26, v58, s53
  ds_add_u64 v56, v[52:53] offset:32
  v_dot2_f32_bf16 v55, v27, v57, s53
  v_dot2_f32_bf16 v54, v27, v58, s53
  ds_add_u64 v56, v[54:55] offset:48
  v_mov_b32_dpp v2, v62 quad_perm:[0,0,2,2] row_mask:0xf bank_mask:0xf
  buffer_load_dwordx4 v[24:27], v[2:3], s[12:15], 0 idxen offen
  s_waitcnt vmcnt(7)
  v_mov_b32_dpp v60, v46 quad_perm:[1,1,3,3] row_mask:0xf bank_mask:0xf
  v_add_u32_dpp v59, v42, v1 quad_perm:[1,1,3,3] row_mask:0xf bank_mask:0xf
  v_lshrrev_b32 v61, 16, v60
  v_dot2_f32_bf16 v49, v28, v60, s53
  v_dot2_f32_bf16 v48, v28, v61, s53
  ds_add_u64 v59, v[48:49] offset:0
  v_dot2_f32_bf16 v51, v29, v60, s53
  v_dot2_f32_bf16 v50, v29, v61, s53
  ds_add_u64 v59, v[50:51] offset:16
  v_dot2_f32_bf16 v53, v30, v60, s53
  v_dot2_f32_bf16 v52, v30, v61, s53
  ds_add_u64 v59, v[52:53] offset:32
  v_dot2_f32_bf16 v55, v31, v60, s53
  v_dot2_f32_bf16 v54, v31, v61, s53
  ds_add_u64 v59, v[54:55] offset:48
  v_mov_b32_dpp v4, v62 quad_perm:[1,1,3,3] row_mask:0xf bank_mask:0xf
  buffer_load_dwordx4 v[28:31], v[4:5], s[12:15], 0 idxen offen
  v_bfe_u32 v63, v114, 19, 11
  v_lshlrev_b32 v64, 16, v90
  v_mad_i32_i24 v42, v63, s58, v6
  v_mul_f32 v46, s54, v64
  ds_add_u32 v42, v7 offset:64
  v_bfi_b32 v62, v115, 0, s57
  s_waitcnt vmcnt(7)
  v_mov_b32_dpp v57, v47 quad_perm:[0,0,2,2] row_mask:0xf bank_mask:0xf
  v_add_u32_dpp v56, v43, v1 quad_perm:[0,0,2,2] row_mask:0xf bank_mask:0xf
  v_lshrrev_b32 v58, 16, v57
  v_dot2_f32_bf16 v49, v32, v57, s53
  v_dot2_f32_bf16 v48, v32, v58, s53
  ds_add_u64 v56, v[48:49] offset:0
  v_dot2_f32_bf16 v51, v33, v57, s53
  v_dot2_f32_bf16 v50, v33, v58, s53
  ds_add_u64 v56, v[50:51] offset:16
  v_dot2_f32_bf16 v53, v34, v57, s53
  v_dot2_f32_bf16 v52, v34, v58, s53
  ds_add_u64 v56, v[52:53] offset:32
  v_dot2_f32_bf16 v55, v35, v57, s53
  v_dot2_f32_bf16 v54, v35, v58, s53
  ds_add_u64 v56, v[54:55] offset:48
  v_mov_b32_dpp v2, v62 quad_perm:[0,0,2,2] row_mask:0xf bank_mask:0xf
  buffer_load_dwordx4 v[32:35], v[2:3], s[12:15], 0 idxen offen
  s_waitcnt vmcnt(7)
  v_mov_b32_dpp v60, v47 quad_perm:[1,1,3,3] row_mask:0xf bank_mask:0xf
  v_add_u32_dpp v59, v43, v1 quad_perm:[1,1,3,3] row_mask:0xf bank_mask:0xf
  v_lshrrev_b32 v61, 16, v60
  v_dot2_f32_bf16 v49, v36, v60, s53
  v_dot2_f32_bf16 v48, v36, v61, s53
  ds_add_u64 v59, v[48:49] offset:0
  v_dot2_f32_bf16 v51, v37, v60, s53
  v_dot2_f32_bf16 v50, v37, v61, s53
  ds_add_u64 v59, v[50:51] offset:16
  v_dot2_f32_bf16 v53, v38, v60, s53
  v_dot2_f32_bf16 v52, v38, v61, s53
  ds_add_u64 v59, v[52:53] offset:32
  v_dot2_f32_bf16 v55, v39, v60, s53
  v_dot2_f32_bf16 v54, v39, v61, s53
  ds_add_u64 v59, v[54:55] offset:48
  v_mov_b32_dpp v4, v62 quad_perm:[1,1,3,3] row_mask:0xf bank_mask:0xf
  buffer_load_dwordx4 v[36:39], v[4:5], s[12:15], 0 idxen offen
  v_bfe_u32 v63, v115, 19, 11
  v_lshlrev_b32 v64, 16, v91
  v_mad_i32_i24 v43, v63, s58, v6
  v_mul_f32 v47, s54, v64
  ds_add_u32 v43, v7 offset:64
  v_and_b32 v64, 63, v0
  v_lshrrev_b32 v63, 4, v64
  v_lshlrev_b32 v64, 6, v63
  v_lshl_add_u32 v64, v77, 1, v64
  global_load_ushort v80, v64, s[72:73] offset:0
  global_load_ushort v110, v64, s[72:73] offset:32
  global_load_ushort v81, v64, s[72:73] offset:256
  global_load_ushort v111, v64, s[72:73] offset:288
  global_load_ushort v86, v64, s[44:45] offset:0
  global_load_ushort v84, v64, s[46:47] offset:0
  global_load_ushort v114, v64, s[44:45] offset:32
  global_load_ushort v115, v64, s[46:47] offset:32
  v_lshlrev_b32 v64, 7, v63
  v_lshl_add_u32 v64, v77, 1, v64
  global_load_ushort v82, v64, s[74:75] offset:0
  global_load_ushort v112, v64, s[74:75] offset:32
  global_load_ushort v83, v64, s[74:75] offset:64
  global_load_ushort v113, v64, s[74:75] offset:96
  v_lshlrev_b32 v64, 2, v63
  global_load_dword v70, v64, s[40:41]
  s_lshl_b32 s80, s50, 5
  v_lshl_add_u32 v64, v77, 1, s80
  buffer_load_ushort v96, v64, s[32:35], 0 offen offset:0
  v_mov_b32 v97, 0
  buffer_load_ushort v98, v64, s[32:35], 0 offen offset:512
  v_mov_b32 v99, 0
  buffer_load_ushort v100, v64, s[32:35], 0 offen offset:1024
  v_mov_b32 v101, 0
  buffer_load_ushort v102, v64, s[32:35], 0 offen offset:1536
  v_mov_b32 v103, 0
  buffer_load_ushort v104, v64, s[32:35], 0 offen offset:2048
  v_mov_b32 v105, 0
  buffer_load_ushort v106, v64, s[32:35], 0 offen offset:2560
  v_mov_b32 v107, 0
  buffer_load_ushort v108, v64, s[32:35], 0 offen offset:3072
  v_mov_b32 v109, 0
  s_barrier
  v_bfi_b32 v62, v116, 0, s57
  s_waitcnt vmcnt(27)
  v_mov_b32_dpp v57, v44 quad_perm:[0,0,2,2] row_mask:0xf bank_mask:0xf
  v_add_u32_dpp v56, v40, v1 quad_perm:[0,0,2,2] row_mask:0xf bank_mask:0xf
  v_lshrrev_b32 v58, 16, v57
  v_dot2_f32_bf16 v49, v8, v57, s53
  v_dot2_f32_bf16 v48, v8, v58, s53
  ds_add_u64 v56, v[48:49] offset:0
  v_dot2_f32_bf16 v51, v9, v57, s53
  v_dot2_f32_bf16 v50, v9, v58, s53
  ds_add_u64 v56, v[50:51] offset:16
  v_dot2_f32_bf16 v53, v10, v57, s53
  v_dot2_f32_bf16 v52, v10, v58, s53
  ds_add_u64 v56, v[52:53] offset:32
  v_dot2_f32_bf16 v55, v11, v57, s53
  v_dot2_f32_bf16 v54, v11, v58, s53
  ds_add_u64 v56, v[54:55] offset:48
  v_mov_b32_dpp v2, v62 quad_perm:[0,0,2,2] row_mask:0xf bank_mask:0xf
  buffer_load_dwordx4 v[8:11], v[2:3], s[12:15], 0 idxen offen
  s_waitcnt vmcnt(27)
  v_mov_b32_dpp v60, v44 quad_perm:[1,1,3,3] row_mask:0xf bank_mask:0xf
  v_add_u32_dpp v59, v40, v1 quad_perm:[1,1,3,3] row_mask:0xf bank_mask:0xf
  v_lshrrev_b32 v61, 16, v60
  v_dot2_f32_bf16 v49, v12, v60, s53
  v_dot2_f32_bf16 v48, v12, v61, s53
  ds_add_u64 v59, v[48:49] offset:0
  v_dot2_f32_bf16 v51, v13, v60, s53
  v_dot2_f32_bf16 v50, v13, v61, s53
  ds_add_u64 v59, v[50:51] offset:16
  v_dot2_f32_bf16 v53, v14, v60, s53
  v_dot2_f32_bf16 v52, v14, v61, s53
  ds_add_u64 v59, v[52:53] offset:32
  v_dot2_f32_bf16 v55, v15, v60, s53
  v_dot2_f32_bf16 v54, v15, v61, s53
  ds_add_u64 v59, v[54:55] offset:48
  v_mov_b32_dpp v4, v62 quad_perm:[1,1,3,3] row_mask:0xf bank_mask:0xf
  buffer_load_dwordx4 v[12:15], v[4:5], s[12:15], 0 idxen offen
  v_bfe_u32 v63, v116, 19, 11
  v_and_b32 v64, 0xffff0000, v88
  v_mad_i32_i24 v40, v63, s58, v6
  v_mul_f32 v44, s54, v64
  ds_add_u32 v40, v7 offset:64
  v_bfi_b32 v62, v117, 0, s57
  s_waitcnt vmcnt(27)
  v_mov_b32_dpp v57, v45 quad_perm:[0,0,2,2] row_mask:0xf bank_mask:0xf
  v_add_u32_dpp v56, v41, v1 quad_perm:[0,0,2,2] row_mask:0xf bank_mask:0xf
  v_lshrrev_b32 v58, 16, v57
  v_dot2_f32_bf16 v49, v16, v57, s53
  v_dot2_f32_bf16 v48, v16, v58, s53
  ds_add_u64 v56, v[48:49] offset:0
  v_dot2_f32_bf16 v51, v17, v57, s53
  v_dot2_f32_bf16 v50, v17, v58, s53
  ds_add_u64 v56, v[50:51] offset:16
  v_dot2_f32_bf16 v53, v18, v57, s53
  v_dot2_f32_bf16 v52, v18, v58, s53
  ds_add_u64 v56, v[52:53] offset:32
  v_dot2_f32_bf16 v55, v19, v57, s53
  v_dot2_f32_bf16 v54, v19, v58, s53
  ds_add_u64 v56, v[54:55] offset:48
  v_mov_b32_dpp v2, v62 quad_perm:[0,0,2,2] row_mask:0xf bank_mask:0xf
  buffer_load_dwordx4 v[16:19], v[2:3], s[12:15], 0 idxen offen
  s_waitcnt vmcnt(27)
  v_mov_b32_dpp v60, v45 quad_perm:[1,1,3,3] row_mask:0xf bank_mask:0xf
  v_add_u32_dpp v59, v41, v1 quad_perm:[1,1,3,3] row_mask:0xf bank_mask:0xf
  v_lshrrev_b32 v61, 16, v60
  v_dot2_f32_bf16 v49, v20, v60, s53
  v_dot2_f32_bf16 v48, v20, v61, s53
  ds_add_u64 v59, v[48:49] offset:0
  v_dot2_f32_bf16 v51, v21, v60, s53
  v_dot2_f32_bf16 v50, v21, v61, s53
  ds_add_u64 v59, v[50:51] offset:16
  v_dot2_f32_bf16 v53, v22, v60, s53
  v_dot2_f32_bf16 v52, v22, v61, s53
  ds_add_u64 v59, v[52:53] offset:32
  v_dot2_f32_bf16 v55, v23, v60, s53
  v_dot2_f32_bf16 v54, v23, v61, s53
  ds_add_u64 v59, v[54:55] offset:48
  v_mov_b32_dpp v4, v62 quad_perm:[1,1,3,3] row_mask:0xf bank_mask:0xf
  buffer_load_dwordx4 v[20:23], v[4:5], s[12:15], 0 idxen offen
  v_bfe_u32 v63, v117, 19, 11
  v_and_b32 v64, 0xffff0000, v89
  v_mad_i32_i24 v41, v63, s58, v6
  v_mul_f32 v45, s54, v64
  ds_add_u32 v41, v7 offset:64
  v_bfi_b32 v62, v118, 0, s57
  s_waitcnt vmcnt(27)
  v_mov_b32_dpp v57, v46 quad_perm:[0,0,2,2] row_mask:0xf bank_mask:0xf
  v_add_u32_dpp v56, v42, v1 quad_perm:[0,0,2,2] row_mask:0xf bank_mask:0xf
  v_lshrrev_b32 v58, 16, v57
  v_dot2_f32_bf16 v49, v24, v57, s53
  v_dot2_f32_bf16 v48, v24, v58, s53
  ds_add_u64 v56, v[48:49] offset:0
  v_dot2_f32_bf16 v51, v25, v57, s53
  v_dot2_f32_bf16 v50, v25, v58, s53
  ds_add_u64 v56, v[50:51] offset:16
  v_dot2_f32_bf16 v53, v26, v57, s53
  v_dot2_f32_bf16 v52, v26, v58, s53
  ds_add_u64 v56, v[52:53] offset:32
  v_dot2_f32_bf16 v55, v27, v57, s53
  v_dot2_f32_bf16 v54, v27, v58, s53
  ds_add_u64 v56, v[54:55] offset:48
  v_mov_b32_dpp v2, v62 quad_perm:[0,0,2,2] row_mask:0xf bank_mask:0xf
  buffer_load_dwordx4 v[24:27], v[2:3], s[12:15], 0 idxen offen
  s_waitcnt vmcnt(27)
  v_mov_b32_dpp v60, v46 quad_perm:[1,1,3,3] row_mask:0xf bank_mask:0xf
  v_add_u32_dpp v59, v42, v1 quad_perm:[1,1,3,3] row_mask:0xf bank_mask:0xf
  v_lshrrev_b32 v61, 16, v60
  v_dot2_f32_bf16 v49, v28, v60, s53
  v_dot2_f32_bf16 v48, v28, v61, s53
  ds_add_u64 v59, v[48:49] offset:0
  v_dot2_f32_bf16 v51, v29, v60, s53
  v_dot2_f32_bf16 v50, v29, v61, s53
  ds_add_u64 v59, v[50:51] offset:16
  v_dot2_f32_bf16 v53, v30, v60, s53
  v_dot2_f32_bf16 v52, v30, v61, s53
  ds_add_u64 v59, v[52:53] offset:32
  v_dot2_f32_bf16 v55, v31, v60, s53
  v_dot2_f32_bf16 v54, v31, v61, s53
  ds_add_u64 v59, v[54:55] offset:48
  v_mov_b32_dpp v4, v62 quad_perm:[1,1,3,3] row_mask:0xf bank_mask:0xf
  buffer_load_dwordx4 v[28:31], v[4:5], s[12:15], 0 idxen offen
  v_bfe_u32 v63, v118, 19, 11
  v_and_b32 v64, 0xffff0000, v90
  v_mad_i32_i24 v42, v63, s58, v6
  v_mul_f32 v46, s54, v64
  ds_add_u32 v42, v7 offset:64
  v_bfi_b32 v62, v119, 0, s57
  s_waitcnt vmcnt(27)
  v_mov_b32_dpp v57, v47 quad_perm:[0,0,2,2] row_mask:0xf bank_mask:0xf
  v_add_u32_dpp v56, v43, v1 quad_perm:[0,0,2,2] row_mask:0xf bank_mask:0xf
  v_lshrrev_b32 v58, 16, v57
  v_dot2_f32_bf16 v49, v32, v57, s53
  v_dot2_f32_bf16 v48, v32, v58, s53
  ds_add_u64 v56, v[48:49] offset:0
  v_dot2_f32_bf16 v51, v33, v57, s53
  v_dot2_f32_bf16 v50, v33, v58, s53
  ds_add_u64 v56, v[50:51] offset:16
  v_dot2_f32_bf16 v53, v34, v57, s53
  v_dot2_f32_bf16 v52, v34, v58, s53
  ds_add_u64 v56, v[52:53] offset:32
  v_dot2_f32_bf16 v55, v35, v57, s53
  v_dot2_f32_bf16 v54, v35, v58, s53
  ds_add_u64 v56, v[54:55] offset:48
  v_mov_b32_dpp v2, v62 quad_perm:[0,0,2,2] row_mask:0xf bank_mask:0xf
  buffer_load_dwordx4 v[32:35], v[2:3], s[12:15], 0 idxen offen
  s_waitcnt vmcnt(27)
  v_mov_b32_dpp v60, v47 quad_perm:[1,1,3,3] row_mask:0xf bank_mask:0xf
  v_add_u32_dpp v59, v43, v1 quad_perm:[1,1,3,3] row_mask:0xf bank_mask:0xf
  v_lshrrev_b32 v61, 16, v60
  v_dot2_f32_bf16 v49, v36, v60, s53
  v_dot2_f32_bf16 v48, v36, v61, s53
  ds_add_u64 v59, v[48:49] offset:0
  v_dot2_f32_bf16 v51, v37, v60, s53
  v_dot2_f32_bf16 v50, v37, v61, s53
  ds_add_u64 v59, v[50:51] offset:16
  v_dot2_f32_bf16 v53, v38, v60, s53
  v_dot2_f32_bf16 v52, v38, v61, s53
  ds_add_u64 v59, v[52:53] offset:32
  v_dot2_f32_bf16 v55, v39, v60, s53
  v_dot2_f32_bf16 v54, v39, v61, s53
  ds_add_u64 v59, v[54:55] offset:48
  v_mov_b32_dpp v4, v62 quad_perm:[1,1,3,3] row_mask:0xf bank_mask:0xf
  buffer_load_dwordx4 v[36:39], v[4:5], s[12:15], 0 idxen offen
  v_bfe_u32 v63, v119, 19, 11
  v_and_b32 v64, 0xffff0000, v91
  v_mad_i32_i24 v43, v63, s58, v6
  v_mul_f32 v47, s54, v64
  ds_add_u32 v43, v7 offset:64
  s_waitcnt vmcnt(8)
  v_lshl_or_b32 v80, v110, 16, v80
  v_lshl_or_b32 v81, v111, 16, v81
  v_lshl_or_b32 v82, v112, 16, v82
  v_lshl_or_b32 v83, v113, 16, v83
  v_lshl_or_b32 v86, v114, 16, v86
  v_lshl_or_b32 v84, v115, 16, v84
  v_mov_b32 v87, 0
  v_mov_b32 v85, 0
  v_lshlrev_b32 v67, 16, v80
  v_and_b32 v68, 0xffff0000, v80
  v_mul_f32 v67, s55, v67
  v_mul_f32 v68, s55, v68
  v_cvt_pk_bf16_f32 v78, v67, v68
  v_lshlrev_b32 v67, 16, v81
  v_and_b32 v68, 0xffff0000, v81
  v_mul_f32 v67, s55, v67
  v_mul_f32 v68, s55, v68
  v_cvt_pk_bf16_f32 v79, v67, v68
  v_lshlrev_b32 v65, 16, v70
  v_and_b32 v66, 0xffff0000, v70
  s_barrier
  v_bfi_b32 v62, v120, 0, s57
  s_waitcnt vmcnt(7)
  v_mov_b32_dpp v57, v44 quad_perm:[0,0,2,2] row_mask:0xf bank_mask:0xf
  v_add_u32_dpp v56, v40, v1 quad_perm:[0,0,2,2] row_mask:0xf bank_mask:0xf
  v_lshrrev_b32 v58, 16, v57
  v_dot2_f32_bf16 v49, v8, v57, s53
  v_dot2_f32_bf16 v48, v8, v58, s53
  ds_add_u64 v56, v[48:49] offset:0
  v_dot2_f32_bf16 v51, v9, v57, s53
  v_dot2_f32_bf16 v50, v9, v58, s53
  ds_add_u64 v56, v[50:51] offset:16
  v_dot2_f32_bf16 v53, v10, v57, s53
  v_dot2_f32_bf16 v52, v10, v58, s53
  ds_add_u64 v56, v[52:53] offset:32
  v_dot2_f32_bf16 v55, v11, v57, s53
  v_dot2_f32_bf16 v54, v11, v58, s53
  ds_add_u64 v56, v[54:55] offset:48
  v_mov_b32_dpp v2, v62 quad_perm:[0,0,2,2] row_mask:0xf bank_mask:0xf
  buffer_load_dwordx4 v[8:11], v[2:3], s[12:15], 0 idxen offen
  s_waitcnt vmcnt(7)
  v_mov_b32_dpp v60, v44 quad_perm:[1,1,3,3] row_mask:0xf bank_mask:0xf
  v_add_u32_dpp v59, v40, v1 quad_perm:[1,1,3,3] row_mask:0xf bank_mask:0xf
  v_lshrrev_b32 v61, 16, v60
  v_dot2_f32_bf16 v49, v12, v60, s53
  v_dot2_f32_bf16 v48, v12, v61, s53
  ds_add_u64 v59, v[48:49] offset:0
  v_dot2_f32_bf16 v51, v13, v60, s53
  v_dot2_f32_bf16 v50, v13, v61, s53
  ds_add_u64 v59, v[50:51] offset:16
  v_dot2_f32_bf16 v53, v14, v60, s53
  v_dot2_f32_bf16 v52, v14, v61, s53
  ds_add_u64 v59, v[52:53] offset:32
  v_dot2_f32_bf16 v55, v15, v60, s53
  v_dot2_f32_bf16 v54, v15, v61, s53
  ds_add_u64 v59, v[54:55] offset:48
  v_mov_b32_dpp v4, v62 quad_perm:[1,1,3,3] row_mask:0xf bank_mask:0xf
  buffer_load_dwordx4 v[12:15], v[4:5], s[12:15], 0 idxen offen
  v_bfe_u32 v63, v120, 19, 11
  v_lshlrev_b32 v64, 16, v92
  v_mad_i32_i24 v40, v63, s58, v6
  v_mul_f32 v44, s54, v64
  ds_add_u32 v40, v7 offset:64
  s_mov_b32 s80, 0xc1200000
  s_mov_b32 s81, 0x3fb8aa3b
  v_lshlrev_b32 v96, 16, v96
  v_sub_f32 v67, v96, v65
  v_sub_f32 v68, v96, v66
  v_cvt_pk_bf16_f32 v69, v67, v68
  v_lshlrev_b32 v67, 16, v69
  v_and_b32 v68, 0xffff0000, v69
  v_mul_f32 v67, v67, v67
  v_mul_f32 v68, v68, v68
  v_cvt_pk_bf16_f32 v69, v67, v68
  v_lshlrev_b32 v67, 16, v69
  v_and_b32 v68, 0xffff0000, v69
  v_mul_f32 v67, s80, v67
  v_mul_f32 v68, s80, v68
  v_cvt_pk_bf16_f32 v69, v67, v68
  v_lshlrev_b32 v67, 16, v69
  v_and_b32 v68, 0xffff0000, v69
  v_mul_f32 v67, s81, v67
  v_mul_f32 v68, s81, v68
  v_exp_f32 v67, v67
  v_exp_f32 v68, v68
  s_nop 0
  v_cvt_pk_bf16_f32 v96, v67, v68
  v_bfi_b32 v62, v121, 0, s57
  s_waitcnt vmcnt(7)
  v_mov_b32_dpp v57, v45 quad_perm:[0,0,2,2] row_mask:0xf bank_mask:0xf
  v_add_u32_dpp v56, v41, v1 quad_perm:[0,0,2,2] row_mask:0xf bank_mask:0xf
  v_lshrrev_b32 v58, 16, v57
  v_dot2_f32_bf16 v49, v16, v57, s53
  v_dot2_f32_bf16 v48, v16, v58, s53
  ds_add_u64 v56, v[48:49] offset:0
  v_dot2_f32_bf16 v51, v17, v57, s53
  v_dot2_f32_bf16 v50, v17, v58, s53
  ds_add_u64 v56, v[50:51] offset:16
  v_dot2_f32_bf16 v53, v18, v57, s53
  v_dot2_f32_bf16 v52, v18, v58, s53
  ds_add_u64 v56, v[52:53] offset:32
  v_dot2_f32_bf16 v55, v19, v57, s53
  v_dot2_f32_bf16 v54, v19, v58, s53
  ds_add_u64 v56, v[54:55] offset:48
  v_mov_b32_dpp v2, v62 quad_perm:[0,0,2,2] row_mask:0xf bank_mask:0xf
  buffer_load_dwordx4 v[16:19], v[2:3], s[12:15], 0 idxen offen
  s_waitcnt vmcnt(7)
  v_mov_b32_dpp v60, v45 quad_perm:[1,1,3,3] row_mask:0xf bank_mask:0xf
  v_add_u32_dpp v59, v41, v1 quad_perm:[1,1,3,3] row_mask:0xf bank_mask:0xf
  v_lshrrev_b32 v61, 16, v60
  v_dot2_f32_bf16 v49, v20, v60, s53
  v_dot2_f32_bf16 v48, v20, v61, s53
  ds_add_u64 v59, v[48:49] offset:0
  v_dot2_f32_bf16 v51, v21, v60, s53
  v_dot2_f32_bf16 v50, v21, v61, s53
  ds_add_u64 v59, v[50:51] offset:16
  v_dot2_f32_bf16 v53, v22, v60, s53
  v_dot2_f32_bf16 v52, v22, v61, s53
  ds_add_u64 v59, v[52:53] offset:32
  v_dot2_f32_bf16 v55, v23, v60, s53
  v_dot2_f32_bf16 v54, v23, v61, s53
  ds_add_u64 v59, v[54:55] offset:48
  v_mov_b32_dpp v4, v62 quad_perm:[1,1,3,3] row_mask:0xf bank_mask:0xf
  buffer_load_dwordx4 v[20:23], v[4:5], s[12:15], 0 idxen offen
  v_bfe_u32 v63, v121, 19, 11
  v_lshlrev_b32 v64, 16, v93
  v_mad_i32_i24 v41, v63, s58, v6
  v_mul_f32 v45, s54, v64
  ds_add_u32 v41, v7 offset:64
  v_cmp_ne_u32 vcc, 0, v73
  s_mov_b64 exec, vcc
  buffer_load_ushort v88, v73, s[8:11], 0 idxen
  buffer_load_dword v73, v73, s[4:7], 0 idxen
  s_mov_b64 exec, -1
  s_mov_b32 s80, 0xc1200000
  s_mov_b32 s81, 0x3fb8aa3b
  v_lshlrev_b32 v98, 16, v98
  v_sub_f32 v67, v98, v65
  v_sub_f32 v68, v98, v66
  v_cvt_pk_bf16_f32 v69, v67, v68
  v_lshlrev_b32 v67, 16, v69
  v_and_b32 v68, 0xffff0000, v69
  v_mul_f32 v67, v67, v67
  v_mul_f32 v68, v68, v68
  v_cvt_pk_bf16_f32 v69, v67, v68
  v_lshlrev_b32 v67, 16, v69
  v_and_b32 v68, 0xffff0000, v69
  v_mul_f32 v67, s80, v67
  v_mul_f32 v68, s80, v68
  v_cvt_pk_bf16_f32 v69, v67, v68
  v_lshlrev_b32 v67, 16, v69
  v_and_b32 v68, 0xffff0000, v69
  v_mul_f32 v67, s81, v67
  v_mul_f32 v68, s81, v68
  v_exp_f32 v67, v67
  v_exp_f32 v68, v68
  s_nop 0
  v_cvt_pk_bf16_f32 v98, v67, v68
  v_bfi_b32 v62, v122, 0, s57
  s_waitcnt vmcnt(9)
  v_mov_b32_dpp v57, v46 quad_perm:[0,0,2,2] row_mask:0xf bank_mask:0xf
  v_add_u32_dpp v56, v42, v1 quad_perm:[0,0,2,2] row_mask:0xf bank_mask:0xf
  v_lshrrev_b32 v58, 16, v57
  v_dot2_f32_bf16 v49, v24, v57, s53
  v_dot2_f32_bf16 v48, v24, v58, s53
  ds_add_u64 v56, v[48:49] offset:0
  v_dot2_f32_bf16 v51, v25, v57, s53
  v_dot2_f32_bf16 v50, v25, v58, s53
  ds_add_u64 v56, v[50:51] offset:16
  v_dot2_f32_bf16 v53, v26, v57, s53
  v_dot2_f32_bf16 v52, v26, v58, s53
  ds_add_u64 v56, v[52:53] offset:32
  v_dot2_f32_bf16 v55, v27, v57, s53
  v_dot2_f32_bf16 v54, v27, v58, s53
  ds_add_u64 v56, v[54:55] offset:48
  v_mov_b32_dpp v2, v62 quad_perm:[0,0,2,2] row_mask:0xf bank_mask:0xf
  buffer_load_dwordx4 v[24:27], v[2:3], s[12:15], 0 idxen offen
  s_waitcnt vmcnt(9)
  v_mov_b32_dpp v60, v46 quad_perm:[1,1,3,3] row_mask:0xf bank_mask:0xf
  v_add_u32_dpp v59, v42, v1 quad_perm:[1,1,3,3] row_mask:0xf bank_mask:0xf
  v_lshrrev_b32 v61, 16, v60
  v_dot2_f32_bf16 v49, v28, v60, s53
  v_dot2_f32_bf16 v48, v28, v61, s53
  ds_add_u64 v59, v[48:49] offset:0
  v_dot2_f32_bf16 v51, v29, v60, s53
  v_dot2_f32_bf16 v50, v29, v61, s53
  ds_add_u64 v59, v[50:51] offset:16
  v_dot2_f32_bf16 v53, v30, v60, s53
  v_dot2_f32_bf16 v52, v30, v61, s53
  ds_add_u64 v59, v[52:53] offset:32
  v_dot2_f32_bf16 v55, v31, v60, s53
  v_dot2_f32_bf16 v54, v31, v61, s53
  ds_add_u64 v59, v[54:55] offset:48
  v_mov_b32_dpp v4, v62 quad_perm:[1,1,3,3] row_mask:0xf bank_mask:0xf
  buffer_load_dwordx4 v[28:31], v[4:5], s[12:15], 0 idxen offen
  v_bfe_u32 v63, v122, 19, 11
  v_lshlrev_b32 v64, 16, v94
  v_mad_i32_i24 v42, v63, s58, v6
  v_mul_f32 v46, s54, v64
  ds_add_u32 v42, v7 offset:64
  v_cmp_ne_u32 vcc, 0, v74
  s_mov_b64 exec, vcc
  buffer_load_ushort v89, v74, s[8:11], 0 idxen
  buffer_load_dword v74, v74, s[4:7], 0 idxen
  s_mov_b64 exec, -1
  s_mov_b32 s80, 0xc1200000
  s_mov_b32 s81, 0x3fb8aa3b
  v_lshlrev_b32 v100, 16, v100
  v_sub_f32 v67, v100, v65
  v_sub_f32 v68, v100, v66
  v_cvt_pk_bf16_f32 v69, v67, v68
  v_lshlrev_b32 v67, 16, v69
  v_and_b32 v68, 0xffff0000, v69
  v_mul_f32 v67, v67, v67
  v_mul_f32 v68, v68, v68
  v_cvt_pk_bf16_f32 v69, v67, v68
  v_lshlrev_b32 v67, 16, v69
  v_and_b32 v68, 0xffff0000, v69
  v_mul_f32 v67, s80, v67
  v_mul_f32 v68, s80, v68
  v_cvt_pk_bf16_f32 v69, v67, v68
  v_lshlrev_b32 v67, 16, v69
  v_and_b32 v68, 0xffff0000, v69
  v_mul_f32 v67, s81, v67
  v_mul_f32 v68, s81, v68
  v_exp_f32 v67, v67
  v_exp_f32 v68, v68
  s_nop 0
  v_cvt_pk_bf16_f32 v100, v67, v68
  v_bfi_b32 v62, v123, 0, s57
  s_waitcnt vmcnt(11)
  v_mov_b32_dpp v57, v47 quad_perm:[0,0,2,2] row_mask:0xf bank_mask:0xf
  v_add_u32_dpp v56, v43, v1 quad_perm:[0,0,2,2] row_mask:0xf bank_mask:0xf
  v_lshrrev_b32 v58, 16, v57
  v_dot2_f32_bf16 v49, v32, v57, s53
  v_dot2_f32_bf16 v48, v32, v58, s53
  ds_add_u64 v56, v[48:49] offset:0
  v_dot2_f32_bf16 v51, v33, v57, s53
  v_dot2_f32_bf16 v50, v33, v58, s53
  ds_add_u64 v56, v[50:51] offset:16
  v_dot2_f32_bf16 v53, v34, v57, s53
  v_dot2_f32_bf16 v52, v34, v58, s53
  ds_add_u64 v56, v[52:53] offset:32
  v_dot2_f32_bf16 v55, v35, v57, s53
  v_dot2_f32_bf16 v54, v35, v58, s53
  ds_add_u64 v56, v[54:55] offset:48
  v_mov_b32_dpp v2, v62 quad_perm:[0,0,2,2] row_mask:0xf bank_mask:0xf
  buffer_load_dwordx4 v[32:35], v[2:3], s[12:15], 0 idxen offen
  s_waitcnt vmcnt(11)
  v_mov_b32_dpp v60, v47 quad_perm:[1,1,3,3] row_mask:0xf bank_mask:0xf
  v_add_u32_dpp v59, v43, v1 quad_perm:[1,1,3,3] row_mask:0xf bank_mask:0xf
  v_lshrrev_b32 v61, 16, v60
  v_dot2_f32_bf16 v49, v36, v60, s53
  v_dot2_f32_bf16 v48, v36, v61, s53
  ds_add_u64 v59, v[48:49] offset:0
  v_dot2_f32_bf16 v51, v37, v60, s53
  v_dot2_f32_bf16 v50, v37, v61, s53
  ds_add_u64 v59, v[50:51] offset:16
  v_dot2_f32_bf16 v53, v38, v60, s53
  v_dot2_f32_bf16 v52, v38, v61, s53
  ds_add_u64 v59, v[52:53] offset:32
  v_dot2_f32_bf16 v55, v39, v60, s53
  v_dot2_f32_bf16 v54, v39, v61, s53
  ds_add_u64 v59, v[54:55] offset:48
  v_mov_b32_dpp v4, v62 quad_perm:[1,1,3,3] row_mask:0xf bank_mask:0xf
  buffer_load_dwordx4 v[36:39], v[4:5], s[12:15], 0 idxen offen
  v_bfe_u32 v63, v123, 19, 11
  v_lshlrev_b32 v64, 16, v95
  v_mad_i32_i24 v43, v63, s58, v6
  v_mul_f32 v47, s54, v64
  ds_add_u32 v43, v7 offset:64
  v_cmp_ne_u32 vcc, 0, v75
  s_mov_b64 exec, vcc
  buffer_load_ushort v90, v75, s[8:11], 0 idxen
  buffer_load_dword v75, v75, s[4:7], 0 idxen
  s_mov_b64 exec, -1
  s_mov_b32 s80, 0xc1200000
  s_mov_b32 s81, 0x3fb8aa3b
  v_lshlrev_b32 v102, 16, v102
  v_sub_f32 v67, v102, v65
  v_sub_f32 v68, v102, v66
  v_cvt_pk_bf16_f32 v69, v67, v68
  v_lshlrev_b32 v67, 16, v69
  v_and_b32 v68, 0xffff0000, v69
  v_mul_f32 v67, v67, v67
  v_mul_f32 v68, v68, v68
  v_cvt_pk_bf16_f32 v69, v67, v68
  v_lshlrev_b32 v67, 16, v69
  v_and_b32 v68, 0xffff0000, v69
  v_mul_f32 v67, s80, v67
  v_mul_f32 v68, s80, v68
  v_cvt_pk_bf16_f32 v69, v67, v68
  v_lshlrev_b32 v67, 16, v69
  v_and_b32 v68, 0xffff0000, v69
  v_mul_f32 v67, s81, v67
  v_mul_f32 v68, s81, v68
  v_exp_f32 v67, v67
  v_exp_f32 v68, v68
  s_nop 0
  v_cvt_pk_bf16_f32 v102, v67, v68
  s_barrier
  v_bfi_b32 v62, v124, 0, s57
  s_waitcnt vmcnt(13)
  v_mov_b32_dpp v57, v44 quad_perm:[0,0,2,2] row_mask:0xf bank_mask:0xf
  v_add_u32_dpp v56, v40, v1 quad_perm:[0,0,2,2] row_mask:0xf bank_mask:0xf
  v_lshrrev_b32 v58, 16, v57
  v_dot2_f32_bf16 v49, v8, v57, s53
  v_dot2_f32_bf16 v48, v8, v58, s53
  ds_add_u64 v56, v[48:49] offset:0
  v_dot2_f32_bf16 v51, v9, v57, s53
  v_dot2_f32_bf16 v50, v9, v58, s53
  ds_add_u64 v56, v[50:51] offset:16
  v_dot2_f32_bf16 v53, v10, v57, s53
  v_dot2_f32_bf16 v52, v10, v58, s53
  ds_add_u64 v56, v[52:53] offset:32
  v_dot2_f32_bf16 v55, v11, v57, s53
  v_dot2_f32_bf16 v54, v11, v58, s53
  ds_add_u64 v56, v[54:55] offset:48
  v_mov_b32_dpp v2, v62 quad_perm:[0,0,2,2] row_mask:0xf bank_mask:0xf
  buffer_load_dwordx4 v[8:11], v[2:3], s[12:15], 0 idxen offen
  s_waitcnt vmcnt(13)
  v_mov_b32_dpp v60, v44 quad_perm:[1,1,3,3] row_mask:0xf bank_mask:0xf
  v_add_u32_dpp v59, v40, v1 quad_perm:[1,1,3,3] row_mask:0xf bank_mask:0xf
  v_lshrrev_b32 v61, 16, v60
  v_dot2_f32_bf16 v49, v12, v60, s53
  v_dot2_f32_bf16 v48, v12, v61, s53
  ds_add_u64 v59, v[48:49] offset:0
  v_dot2_f32_bf16 v51, v13, v60, s53
  v_dot2_f32_bf16 v50, v13, v61, s53
  ds_add_u64 v59, v[50:51] offset:16
  v_dot2_f32_bf16 v53, v14, v60, s53
  v_dot2_f32_bf16 v52, v14, v61, s53
  ds_add_u64 v59, v[52:53] offset:32
  v_dot2_f32_bf16 v55, v15, v60, s53
  v_dot2_f32_bf16 v54, v15, v61, s53
  ds_add_u64 v59, v[54:55] offset:48
  v_mov_b32_dpp v4, v62 quad_perm:[1,1,3,3] row_mask:0xf bank_mask:0xf
  buffer_load_dwordx4 v[12:15], v[4:5], s[12:15], 0 idxen offen
  v_bfe_u32 v63, v124, 19, 11
  v_and_b32 v64, 0xffff0000, v92
  v_mad_i32_i24 v40, v63, s58, v6
  v_mul_f32 v44, s54, v64
  ds_add_u32 v40, v7 offset:64
  v_cmp_ne_u32 vcc, 0, v76
  s_mov_b64 exec, vcc
  buffer_load_ushort v91, v76, s[8:11], 0 idxen
  buffer_load_dword v76, v76, s[4:7], 0 idxen
  s_mov_b64 exec, -1
  s_mov_b32 s80, 0xc1200000
  s_mov_b32 s81, 0x3fb8aa3b
  v_lshlrev_b32 v104, 16, v104
  v_sub_f32 v67, v104, v65
  v_sub_f32 v68, v104, v66
  v_cvt_pk_bf16_f32 v69, v67, v68
  v_lshlrev_b32 v67, 16, v69
  v_and_b32 v68, 0xffff0000, v69
  v_mul_f32 v67, v67, v67
  v_mul_f32 v68, v68, v68
  v_cvt_pk_bf16_f32 v69, v67, v68
  v_lshlrev_b32 v67, 16, v69
  v_and_b32 v68, 0xffff0000, v69
  v_mul_f32 v67, s80, v67
  v_mul_f32 v68, s80, v68
  v_cvt_pk_bf16_f32 v69, v67, v68
  v_lshlrev_b32 v67, 16, v69
  v_and_b32 v68, 0xffff0000, v69
  v_mul_f32 v67, s81, v67
  v_mul_f32 v68, s81, v68
  v_exp_f32 v67, v67
  v_exp_f32 v68, v68
  s_nop 0
  v_cvt_pk_bf16_f32 v104, v67, v68
  v_bfi_b32 v62, v125, 0, s57
  s_waitcnt vmcnt(15)
  v_mov_b32_dpp v57, v45 quad_perm:[0,0,2,2] row_mask:0xf bank_mask:0xf
  v_add_u32_dpp v56, v41, v1 quad_perm:[0,0,2,2] row_mask:0xf bank_mask:0xf
  v_lshrrev_b32 v58, 16, v57
  v_dot2_f32_bf16 v49, v16, v57, s53
  v_dot2_f32_bf16 v48, v16, v58, s53
  ds_add_u64 v56, v[48:49] offset:0
  v_dot2_f32_bf16 v51, v17, v57, s53
  v_dot2_f32_bf16 v50, v17, v58, s53
  ds_add_u64 v56, v[50:51] offset:16
  v_dot2_f32_bf16 v53, v18, v57, s53
  v_dot2_f32_bf16 v52, v18, v58, s53
  ds_add_u64 v56, v[52:53] offset:32
  v_dot2_f32_bf16 v55, v19, v57, s53
  v_dot2_f32_bf16 v54, v19, v58, s53
  ds_add_u64 v56, v[54:55] offset:48
  v_mov_b32_dpp v2, v62 quad_perm:[0,0,2,2] row_mask:0xf bank_mask:0xf
  buffer_load_dwordx4 v[16:19], v[2:3], s[12:15], 0 idxen offen
  s_waitcnt vmcnt(15)
  v_mov_b32_dpp v60, v45 quad_perm:[1,1,3,3] row_mask:0xf bank_mask:0xf
  v_add_u32_dpp v59, v41, v1 quad_perm:[1,1,3,3] row_mask:0xf bank_mask:0xf
  v_lshrrev_b32 v61, 16, v60
  v_dot2_f32_bf16 v49, v20, v60, s53
  v_dot2_f32_bf16 v48, v20, v61, s53
  ds_add_u64 v59, v[48:49] offset:0
  v_dot2_f32_bf16 v51, v21, v60, s53
  v_dot2_f32_bf16 v50, v21, v61, s53
  ds_add_u64 v59, v[50:51] offset:16
  v_dot2_f32_bf16 v53, v22, v60, s53
  v_dot2_f32_bf16 v52, v22, v61, s53
  ds_add_u64 v59, v[52:53] offset:32
  v_dot2_f32_bf16 v55, v23, v60, s53
  v_dot2_f32_bf16 v54, v23, v61, s53
  ds_add_u64 v59, v[54:55] offset:48
  v_mov_b32_dpp v4, v62 quad_perm:[1,1,3,3] row_mask:0xf bank_mask:0xf
  buffer_load_dwordx4 v[20:23], v[4:5], s[12:15], 0 idxen offen
  v_bfe_u32 v63, v125, 19, 11
  v_and_b32 v64, 0xffff0000, v93
  v_mad_i32_i24 v41, v63, s58, v6
  v_mul_f32 v45, s54, v64
  ds_add_u32 v41, v7 offset:64
  s_mov_b32 s80, 0xc1200000
  s_mov_b32 s81, 0x3fb8aa3b
  v_lshlrev_b32 v106, 16, v106
  v_sub_f32 v67, v106, v65
  v_sub_f32 v68, v106, v66
  v_cvt_pk_bf16_f32 v69, v67, v68
  v_lshlrev_b32 v67, 16, v69
  v_and_b32 v68, 0xffff0000, v69
  v_mul_f32 v67, v67, v67
  v_mul_f32 v68, v68, v68
  v_cvt_pk_bf16_f32 v69, v67, v68
  v_lshlrev_b32 v67, 16, v69
  v_and_b32 v68, 0xffff0000, v69
  v_mul_f32 v67, s80, v67
  v_mul_f32 v68, s80, v68
  v_cvt_pk_bf16_f32 v69, v67, v68
  v_lshlrev_b32 v67, 16, v69
  v_and_b32 v68, 0xffff0000, v69
  v_mul_f32 v67, s81, v67
  v_mul_f32 v68, s81, v68
  v_exp_f32 v67, v67
  v_exp_f32 v68, v68
  s_nop 0
  v_cvt_pk_bf16_f32 v106, v67, v68
  v_bfi_b32 v62, v126, 0, s57
  s_waitcnt vmcnt(13)
  v_mov_b32_dpp v57, v46 quad_perm:[0,0,2,2] row_mask:0xf bank_mask:0xf
  v_add_u32_dpp v56, v42, v1 quad_perm:[0,0,2,2] row_mask:0xf bank_mask:0xf
  v_lshrrev_b32 v58, 16, v57
  v_dot2_f32_bf16 v49, v24, v57, s53
  v_dot2_f32_bf16 v48, v24, v58, s53
  ds_add_u64 v56, v[48:49] offset:0
  v_dot2_f32_bf16 v51, v25, v57, s53
  v_dot2_f32_bf16 v50, v25, v58, s53
  ds_add_u64 v56, v[50:51] offset:16
  v_dot2_f32_bf16 v53, v26, v57, s53
  v_dot2_f32_bf16 v52, v26, v58, s53
  ds_add_u64 v56, v[52:53] offset:32
  v_dot2_f32_bf16 v55, v27, v57, s53
  v_dot2_f32_bf16 v54, v27, v58, s53
  ds_add_u64 v56, v[54:55] offset:48
  v_mov_b32_dpp v2, v62 quad_perm:[0,0,2,2] row_mask:0xf bank_mask:0xf
  buffer_load_dwordx4 v[24:27], v[2:3], s[12:15], 0 idxen offen
  s_waitcnt vmcnt(13)
  v_mov_b32_dpp v60, v46 quad_perm:[1,1,3,3] row_mask:0xf bank_mask:0xf
  v_add_u32_dpp v59, v42, v1 quad_perm:[1,1,3,3] row_mask:0xf bank_mask:0xf
  v_lshrrev_b32 v61, 16, v60
  v_dot2_f32_bf16 v49, v28, v60, s53
  v_dot2_f32_bf16 v48, v28, v61, s53
  ds_add_u64 v59, v[48:49] offset:0
  v_dot2_f32_bf16 v51, v29, v60, s53
  v_dot2_f32_bf16 v50, v29, v61, s53
  ds_add_u64 v59, v[50:51] offset:16
  v_dot2_f32_bf16 v53, v30, v60, s53
  v_dot2_f32_bf16 v52, v30, v61, s53
  ds_add_u64 v59, v[52:53] offset:32
  v_dot2_f32_bf16 v55, v31, v60, s53
  v_dot2_f32_bf16 v54, v31, v61, s53
  ds_add_u64 v59, v[54:55] offset:48
  v_mov_b32_dpp v4, v62 quad_perm:[1,1,3,3] row_mask:0xf bank_mask:0xf
  buffer_load_dwordx4 v[28:31], v[4:5], s[12:15], 0 idxen offen
  v_bfe_u32 v63, v126, 19, 11
  v_and_b32 v64, 0xffff0000, v94
  v_mad_i32_i24 v42, v63, s58, v6
  v_mul_f32 v46, s54, v64
  ds_add_u32 v42, v7 offset:64
  s_mov_b32 s80, 0xc1200000
  s_mov_b32 s81, 0x3fb8aa3b
  v_lshlrev_b32 v108, 16, v108
  v_sub_f32 v67, v108, v65
  v_sub_f32 v68, v108, v66
  v_cvt_pk_bf16_f32 v69, v67, v68
  v_lshlrev_b32 v67, 16, v69
  v_and_b32 v68, 0xffff0000, v69
  v_mul_f32 v67, v67, v67
  v_mul_f32 v68, v68, v68
  v_cvt_pk_bf16_f32 v69, v67, v68
  v_lshlrev_b32 v67, 16, v69
  v_and_b32 v68, 0xffff0000, v69
  v_mul_f32 v67, s80, v67
  v_mul_f32 v68, s80, v68
  v_cvt_pk_bf16_f32 v69, v67, v68
  v_lshlrev_b32 v67, 16, v69
  v_and_b32 v68, 0xffff0000, v69
  v_mul_f32 v67, s81, v67
  v_mul_f32 v68, s81, v68
  v_exp_f32 v67, v67
  v_exp_f32 v68, v68
  s_nop 0
  v_cvt_pk_bf16_f32 v108, v67, v68
  v_bfi_b32 v62, v127, 0, s57
  s_waitcnt vmcnt(11)
  v_mov_b32_dpp v57, v47 quad_perm:[0,0,2,2] row_mask:0xf bank_mask:0xf
  v_add_u32_dpp v56, v43, v1 quad_perm:[0,0,2,2] row_mask:0xf bank_mask:0xf
  v_lshrrev_b32 v58, 16, v57
  v_dot2_f32_bf16 v49, v32, v57, s53
  v_dot2_f32_bf16 v48, v32, v58, s53
  ds_add_u64 v56, v[48:49] offset:0
  v_dot2_f32_bf16 v51, v33, v57, s53
  v_dot2_f32_bf16 v50, v33, v58, s53
  ds_add_u64 v56, v[50:51] offset:16
  v_dot2_f32_bf16 v53, v34, v57, s53
  v_dot2_f32_bf16 v52, v34, v58, s53
  ds_add_u64 v56, v[52:53] offset:32
  v_dot2_f32_bf16 v55, v35, v57, s53
  v_dot2_f32_bf16 v54, v35, v58, s53
  ds_add_u64 v56, v[54:55] offset:48
  v_mov_b32_dpp v2, v62 quad_perm:[0,0,2,2] row_mask:0xf bank_mask:0xf
  buffer_load_dwordx4 v[32:35], v[2:3], s[12:15], 0 idxen offen
  s_waitcnt vmcnt(11)
  v_mov_b32_dpp v60, v47 quad_perm:[1,1,3,3] row_mask:0xf bank_mask:0xf
  v_add_u32_dpp v59, v43, v1 quad_perm:[1,1,3,3] row_mask:0xf bank_mask:0xf
  v_lshrrev_b32 v61, 16, v60
  v_dot2_f32_bf16 v49, v36, v60, s53
  v_dot2_f32_bf16 v48, v36, v61, s53
  ds_add_u64 v59, v[48:49] offset:0
  v_dot2_f32_bf16 v51, v37, v60, s53
  v_dot2_f32_bf16 v50, v37, v61, s53
  ds_add_u64 v59, v[50:51] offset:16
  v_dot2_f32_bf16 v53, v38, v60, s53
  v_dot2_f32_bf16 v52, v38, v61, s53
  ds_add_u64 v59, v[52:53] offset:32
  v_dot2_f32_bf16 v55, v39, v60, s53
  v_dot2_f32_bf16 v54, v39, v61, s53
  ds_add_u64 v59, v[54:55] offset:48
  v_mov_b32_dpp v4, v62 quad_perm:[1,1,3,3] row_mask:0xf bank_mask:0xf
  buffer_load_dwordx4 v[36:39], v[4:5], s[12:15], 0 idxen offen
  v_bfe_u32 v63, v127, 19, 11
  v_and_b32 v64, 0xffff0000, v95
  v_mad_i32_i24 v43, v63, s58, v6
  v_mul_f32 v47, s54, v64
  ds_add_u32 v43, v7 offset:64
  v_and_b32 v64, 63, v0
  v_lshrrev_b32 v63, 4, v64
  s_lshl_b32 s80, s50, 9
  v_lshlrev_b32 v64, 5, v77
  v_lshl_add_u32 v64, v63, 3, v64
  v_add_u32 v64, s80, v64
  s_mov_b32 s81, 0
  buffer_load_dwordx2 v[110:111], v64, s[24:27], s81 offen
  s_mov_b32 s81, 8192
  buffer_load_dwordx2 v[112:113], v64, s[24:27], s81 offen
  s_mov_b32 s81, 16384
  buffer_load_dwordx2 v[114:115], v64, s[24:27], s81 offen
  s_mov_b32 s81, 24576
  buffer_load_dwordx2 v[116:117], v64, s[24:27], s81 offen
  s_mov_b32 s81, 32768
  buffer_load_dwordx2 v[118:119], v64, s[24:27], s81 offen
  s_mov_b32 s81, 40960
  buffer_load_dwordx2 v[120:121], v64, s[24:27], s81 offen
  s_mov_b32 s81, 49152
  buffer_load_dwordx2 v[122:123], v64, s[24:27], s81 offen
  s_waitcnt vmcnt(16)
  v_mov_b32_dpp v57, v44 quad_perm:[0,0,2,2] row_mask:0xf bank_mask:0xf
  v_add_u32_dpp v56, v40, v1 quad_perm:[0,0,2,2] row_mask:0xf bank_mask:0xf
  v_lshrrev_b32 v58, 16, v57
  v_dot2_f32_bf16 v49, v8, v57, s53
  v_dot2_f32_bf16 v48, v8, v58, s53
  ds_add_u64 v56, v[48:49] offset:0
  v_dot2_f32_bf16 v51, v9, v57, s53
  v_dot2_f32_bf16 v50, v9, v58, s53
  ds_add_u64 v56, v[50:51] offset:16
  v_dot2_f32_bf16 v53, v10, v57, s53
  v_dot2_f32_bf16 v52, v10, v58, s53
  ds_add_u64 v56, v[52:53] offset:32
  v_dot2_f32_bf16 v55, v11, v57, s53
  v_dot2_f32_bf16 v54, v11, v58, s53
  ds_add_u64 v56, v[54:55] offset:48
  s_waitcnt vmcnt(15)
  v_mov_b32_dpp v60, v44 quad_perm:[1,1,3,3] row_mask:0xf bank_mask:0xf
  v_add_u32_dpp v59, v40, v1 quad_perm:[1,1,3,3] row_mask:0xf bank_mask:0xf
  v_lshrrev_b32 v61, 16, v60
  v_dot2_f32_bf16 v49, v12, v60, s53
  v_dot2_f32_bf16 v48, v12, v61, s53
  ds_add_u64 v59, v[48:49] offset:0
  v_dot2_f32_bf16 v51, v13, v60, s53
  v_dot2_f32_bf16 v50, v13, v61, s53
  ds_add_u64 v59, v[50:51] offset:16
  v_dot2_f32_bf16 v53, v14, v60, s53
  v_dot2_f32_bf16 v52, v14, v61, s53
  ds_add_u64 v59, v[52:53] offset:32
  v_dot2_f32_bf16 v55, v15, v60, s53
  v_dot2_f32_bf16 v54, v15, v61, s53
  ds_add_u64 v59, v[54:55] offset:48
  s_waitcnt vmcnt(12)
  v_mov_b32_dpp v57, v45 quad_perm:[0,0,2,2] row_mask:0xf bank_mask:0xf
  v_add_u32_dpp v56, v41, v1 quad_perm:[0,0,2,2] row_mask:0xf bank_mask:0xf
  v_lshrrev_b32 v58, 16, v57
  v_dot2_f32_bf16 v49, v16, v57, s53
  v_dot2_f32_bf16 v48, v16, v58, s53
  ds_add_u64 v56, v[48:49] offset:0
  v_dot2_f32_bf16 v51, v17, v57, s53
  v_dot2_f32_bf16 v50, v17, v58, s53
  ds_add_u64 v56, v[50:51] offset:16
  v_dot2_f32_bf16 v53, v18, v57, s53
  v_dot2_f32_bf16 v52, v18, v58, s53
  ds_add_u64 v56, v[52:53] offset:32
  v_dot2_f32_bf16 v55, v19, v57, s53
  v_dot2_f32_bf16 v54, v19, v58, s53
  ds_add_u64 v56, v[54:55] offset:48
  s_waitcnt vmcnt(11)
  v_mov_b32_dpp v60, v45 quad_perm:[1,1,3,3] row_mask:0xf bank_mask:0xf
  v_add_u32_dpp v59, v41, v1 quad_perm:[1,1,3,3] row_mask:0xf bank_mask:0xf
  v_lshrrev_b32 v61, 16, v60
  v_dot2_f32_bf16 v49, v20, v60, s53
  v_dot2_f32_bf16 v48, v20, v61, s53
  ds_add_u64 v59, v[48:49] offset:0
  v_dot2_f32_bf16 v51, v21, v60, s53
  v_dot2_f32_bf16 v50, v21, v61, s53
  ds_add_u64 v59, v[50:51] offset:16
  v_dot2_f32_bf16 v53, v22, v60, s53
  v_dot2_f32_bf16 v52, v22, v61, s53
  ds_add_u64 v59, v[52:53] offset:32
  v_dot2_f32_bf16 v55, v23, v60, s53
  v_dot2_f32_bf16 v54, v23, v61, s53
  ds_add_u64 v59, v[54:55] offset:48
  s_waitcnt vmcnt(10)
  v_mov_b32_dpp v57, v46 quad_perm:[0,0,2,2] row_mask:0xf bank_mask:0xf
  v_add_u32_dpp v56, v42, v1 quad_perm:[0,0,2,2] row_mask:0xf bank_mask:0xf
  v_lshrrev_b32 v58, 16, v57
  v_dot2_f32_bf16 v49, v24, v57, s53
  v_dot2_f32_bf16 v48, v24, v58, s53
  ds_add_u64 v56, v[48:49] offset:0
  v_dot2_f32_bf16 v51, v25, v57, s53
  v_dot2_f32_bf16 v50, v25, v58, s53
  ds_add_u64 v56, v[50:51] offset:16
  v_dot2_f32_bf16 v53, v26, v57, s53
  v_dot2_f32_bf16 v52, v26, v58, s53
  ds_add_u64 v56, v[52:53] offset:32
  v_dot2_f32_bf16 v55, v27, v57, s53
  v_dot2_f32_bf16 v54, v27, v58, s53
  ds_add_u64 v56, v[54:55] offset:48
  s_waitcnt vmcnt(9)
  v_mov_b32_dpp v60, v46 quad_perm:[1,1,3,3] row_mask:0xf bank_mask:0xf
  v_add_u32_dpp v59, v42, v1 quad_perm:[1,1,3,3] row_mask:0xf bank_mask:0xf
  v_lshrrev_b32 v61, 16, v60
  v_dot2_f32_bf16 v49, v28, v60, s53
  v_dot2_f32_bf16 v48, v28, v61, s53
  ds_add_u64 v59, v[48:49] offset:0
  v_dot2_f32_bf16 v51, v29, v60, s53
  v_dot2_f32_bf16 v50, v29, v61, s53
  ds_add_u64 v59, v[50:51] offset:16
  v_dot2_f32_bf16 v53, v30, v60, s53
  v_dot2_f32_bf16 v52, v30, v61, s53
  ds_add_u64 v59, v[52:53] offset:32
  v_dot2_f32_bf16 v55, v31, v60, s53
  v_dot2_f32_bf16 v54, v31, v61, s53
  ds_add_u64 v59, v[54:55] offset:48
  s_waitcnt vmcnt(8)
  v_mov_b32_dpp v57, v47 quad_perm:[0,0,2,2] row_mask:0xf bank_mask:0xf
  v_add_u32_dpp v56, v43, v1 quad_perm:[0,0,2,2] row_mask:0xf bank_mask:0xf
  v_lshrrev_b32 v58, 16, v57
  v_dot2_f32_bf16 v49, v32, v57, s53
  v_dot2_f32_bf16 v48, v32, v58, s53
  ds_add_u64 v56, v[48:49] offset:0
  v_dot2_f32_bf16 v51, v33, v57, s53
  v_dot2_f32_bf16 v50, v33, v58, s53
  ds_add_u64 v56, v[50:51] offset:16
  v_dot2_f32_bf16 v53, v34, v57, s53
  v_dot2_f32_bf16 v52, v34, v58, s53
  ds_add_u64 v56, v[52:53] offset:32
  v_dot2_f32_bf16 v55, v35, v57, s53
  v_dot2_f32_bf16 v54, v35, v58, s53
  ds_add_u64 v56, v[54:55] offset:48
  s_waitcnt vmcnt(7)
  v_mov_b32_dpp v60, v47 quad_perm:[1,1,3,3] row_mask:0xf bank_mask:0xf
  v_add_u32_dpp v59, v43, v1 quad_perm:[1,1,3,3] row_mask:0xf bank_mask:0xf
  v_lshrrev_b32 v61, 16, v60
  v_dot2_f32_bf16 v49, v36, v60, s53
  v_dot2_f32_bf16 v48, v36, v61, s53
  ds_add_u64 v59, v[48:49] offset:0
  v_dot2_f32_bf16 v51, v37, v60, s53
  v_dot2_f32_bf16 v50, v37, v61, s53
  ds_add_u64 v59, v[50:51] offset:16
  v_dot2_f32_bf16 v53, v38, v60, s53
  v_dot2_f32_bf16 v52, v38, v61, s53
  ds_add_u64 v59, v[52:53] offset:32
  v_dot2_f32_bf16 v55, v39, v60, s53
  v_dot2_f32_bf16 v54, v39, v61, s53
  ds_add_u64 v59, v[54:55] offset:48
  s_cmp_eq_u32 s59, 0
  s_cbranch_scc1 LB_epi
  s_waitcnt vmcnt(0)
  v_bfi_b32 v62, v73, 0, s57
  v_bfe_u32 v63, v73, 19, 11
  v_lshlrev_b32 v64, 16, v88
  v_mad_i32_i24 v40, v63, s58, v6
  v_mul_f32 v44, s54, v64
  ds_add_u32 v40, v7 offset:64
  v_mov_b32_dpp v2, v62 quad_perm:[0,0,2,2] row_mask:0xf bank_mask:0xf
  buffer_load_dwordx4 v[8:11], v[2:3], s[12:15], 0 idxen offen
  v_mov_b32_dpp v4, v62 quad_perm:[1,1,3,3] row_mask:0xf bank_mask:0xf
  buffer_load_dwordx4 v[12:15], v[4:5], s[12:15], 0 idxen offen
  v_bfi_b32 v62, v74, 0, s57
  v_bfe_u32 v63, v74, 19, 11
  v_lshlrev_b32 v64, 16, v89
  v_mad_i32_i24 v41, v63, s58, v6
  v_mul_f32 v45, s54, v64
  ds_add_u32 v41, v7 offset:64
  v_mov_b32_dpp v2, v62 quad_perm:[0,0,2,2] row_mask:0xf bank_mask:0xf
  buffer_load_dwordx4 v[16:19], v[2:3], s[12:15], 0 idxen offen
  v_mov_b32_dpp v4, v62 quad_perm:[1,1,3,3] row_mask:0xf bank_mask:0xf
  buffer_load_dwordx4 v[20:23], v[4:5], s[12:15], 0 idxen offen
  v_bfi_b32 v62, v75, 0, s57
  v_bfe_u32 v63, v75, 19, 11
  v_lshlrev_b32 v64, 16, v90
  v_mad_i32_i24 v42, v63, s58, v6
  v_mul_f32 v46, s54, v64
  ds_add_u32 v42, v7 offset:64
  v_mov_b32_dpp v2, v62 quad_perm:[0,0,2,2] row_mask:0xf bank_mask:0xf
  buffer_load_dwordx4 v[24:27], v[2:3], s[12:15], 0 idxen offen
  v_mov_b32_dpp v4, v62 quad_perm:[1,1,3,3] row_mask:0xf bank_mask:0xf
  buffer_load_dwordx4 v[28:31], v[4:5], s[12:15], 0 idxen offen
  v_bfi_b32 v62, v76, 0, s57
  v_bfe_u32 v63, v76, 19, 11
  v_lshlrev_b32 v64, 16, v91
  v_mad_i32_i24 v43, v63, s58, v6
  v_mul_f32 v47, s54, v64
  ds_add_u32 v43, v7 offset:64
  v_mov_b32_dpp v2, v62 quad_perm:[0,0,2,2] row_mask:0xf bank_mask:0xf
  buffer_load_dwordx4 v[32:35], v[2:3], s[12:15], 0 idxen offen
  v_mov_b32_dpp v4, v62 quad_perm:[1,1,3,3] row_mask:0xf bank_mask:0xf
  buffer_load_dwordx4 v[36:39], v[4:5], s[12:15], 0 idxen offen
  s_waitcnt vmcnt(0)
  v_mov_b32_dpp v57, v44 quad_perm:[0,0,2,2] row_mask:0xf bank_mask:0xf
  v_add_u32_dpp v56, v40, v1 quad_perm:[0,0,2,2] row_mask:0xf bank_mask:0xf
  v_lshrrev_b32 v58, 16, v57
  v_dot2_f32_bf16 v49, v8, v57, s53
  v_dot2_f32_bf16 v48, v8, v58, s53
  ds_add_u64 v56, v[48:49] offset:0
  v_dot2_f32_bf16 v51, v9, v57, s53
  v_dot2_f32_bf16 v50, v9, v58, s53
  ds_add_u64 v56, v[50:51] offset:16
  v_dot2_f32_bf16 v53, v10, v57, s53
  v_dot2_f32_bf16 v52, v10, v58, s53
  ds_add_u64 v56, v[52:53] offset:32
  v_dot2_f32_bf16 v55, v11, v57, s53
  v_dot2_f32_bf16 v54, v11, v58, s53
  ds_add_u64 v56, v[54:55] offset:48
  v_mov_b32_dpp v60, v44 quad_perm:[1,1,3,3] row_mask:0xf bank_mask:0xf
  v_add_u32_dpp v59, v40, v1 quad_perm:[1,1,3,3] row_mask:0xf bank_mask:0xf
  v_lshrrev_b32 v61, 16, v60
  v_dot2_f32_bf16 v49, v12, v60, s53
  v_dot2_f32_bf16 v48, v12, v61, s53
  ds_add_u64 v59, v[48:49] offset:0
  v_dot2_f32_bf16 v51, v13, v60, s53
  v_dot2_f32_bf16 v50, v13, v61, s53
  ds_add_u64 v59, v[50:51] offset:16
  v_dot2_f32_bf16 v53, v14, v60, s53
  v_dot2_f32_bf16 v52, v14, v61, s53
  ds_add_u64 v59, v[52:53] offset:32
  v_dot2_f32_bf16 v55, v15, v60, s53
  v_dot2_f32_bf16 v54, v15, v61, s53
  ds_add_u64 v59, v[54:55] offset:48
  v_mov_b32_dpp v57, v45 quad_perm:[0,0,2,2] row_mask:0xf bank_mask:0xf
  v_add_u32_dpp v56, v41, v1 quad_perm:[0,0,2,2] row_mask:0xf bank_mask:0xf
  v_lshrrev_b32 v58, 16, v57
  v_dot2_f32_bf16 v49, v16, v57, s53
  v_dot2_f32_bf16 v48, v16, v58, s53
  ds_add_u64 v56, v[48:49] offset:0
  v_dot2_f32_bf16 v51, v17, v57, s53
  v_dot2_f32_bf16 v50, v17, v58, s53
  ds_add_u64 v56, v[50:51] offset:16
  v_dot2_f32_bf16 v53, v18, v57, s53
  v_dot2_f32_bf16 v52, v18, v58, s53
  ds_add_u64 v56, v[52:53] offset:32
  v_dot2_f32_bf16 v55, v19, v57, s53
  v_dot2_f32_bf16 v54, v19, v58, s53
  ds_add_u64 v56, v[54:55] offset:48
  v_mov_b32_dpp v60, v45 quad_perm:[1,1,3,3] row_mask:0xf bank_mask:0xf
  v_add_u32_dpp v59, v41, v1 quad_perm:[1,1,3,3] row_mask:0xf bank_mask:0xf
  v_lshrrev_b32 v61, 16, v60
  v_dot2_f32_bf16 v49, v20, v60, s53
  v_dot2_f32_bf16 v48, v20, v61, s53
  ds_add_u64 v59, v[48:49] offset:0
  v_dot2_f32_bf16 v51, v21, v60, s53
  v_dot2_f32_bf16 v50, v21, v61, s53
  ds_add_u64 v59, v[50:51] offset:16
  v_dot2_f32_bf16 v53, v22, v60, s53
  v_dot2_f32_bf16 v52, v22, v61, s53
  ds_add_u64 v59, v[52:53] offset:32
  v_dot2_f32_bf16 v55, v23, v60, s53
  v_dot2_f32_bf16 v54, v23, v61, s53
  ds_add_u64 v59, v[54:55] offset:48
  v_mov_b32_dpp v57, v46 quad_perm:[0,0,2,2] row_mask:0xf bank_mask:0xf
  v_add_u32_dpp v56, v42, v1 quad_perm:[0,0,2,2] row_mask:0xf bank_mask:0xf
  v_lshrrev_b32 v58, 16, v57
  v_dot2_f32_bf16 v49, v24, v57, s53
  v_dot2_f32_bf16 v48, v24, v58, s53
  ds_add_u64 v56, v[48:49] offset:0
  v_dot2_f32_bf16 v51, v25, v57, s53
  v_dot2_f32_bf16 v50, v25, v58, s53
  ds_add_u64 v56, v[50:51] offset:16
  v_dot2_f32_bf16 v53, v26, v57, s53
  v_dot2_f32_bf16 v52, v26, v58, s53
  ds_add_u64 v56, v[52:53] offset:32
  v_dot2_f32_bf16 v55, v27, v57, s53
  v_dot2_f32_bf16 v54, v27, v58, s53
  ds_add_u64 v56, v[54:55] offset:48
  v_mov_b32_dpp v60, v46 quad_perm:[1,1,3,3] row_mask:0xf bank_mask:0xf
  v_add_u32_dpp v59, v42, v1 quad_perm:[1,1,3,3] row_mask:0xf bank_mask:0xf
  v_lshrrev_b32 v61, 16, v60
  v_dot2_f32_bf16 v49, v28, v60, s53
  v_dot2_f32_bf16 v48, v28, v61, s53
  ds_add_u64 v59, v[48:49] offset:0
  v_dot2_f32_bf16 v51, v29, v60, s53
  v_dot2_f32_bf16 v50, v29, v61, s53
  ds_add_u64 v59, v[50:51] offset:16
  v_dot2_f32_bf16 v53, v30, v60, s53
  v_dot2_f32_bf16 v52, v30, v61, s53
  ds_add_u64 v59, v[52:53] offset:32
  v_dot2_f32_bf16 v55, v31, v60, s53
  v_dot2_f32_bf16 v54, v31, v61, s53
  ds_add_u64 v59, v[54:55] offset:48
  v_mov_b32_dpp v57, v47 quad_perm:[0,0,2,2] row_mask:0xf bank_mask:0xf
  v_add_u32_dpp v56, v43, v1 quad_perm:[0,0,2,2] row_mask:0xf bank_mask:0xf
  v_lshrrev_b32 v58, 16, v57
  v_dot2_f32_bf16 v49, v32, v57, s53
  v_dot2_f32_bf16 v48, v32, v58, s53
  ds_add_u64 v56, v[48:49] offset:0
  v_dot2_f32_bf16 v51, v33, v57, s53
  v_dot2_f32_bf16 v50, v33, v58, s53
  ds_add_u64 v56, v[50:51] offset:16
  v_dot2_f32_bf16 v53, v34, v57, s53
  v_dot2_f32_bf16 v52, v34, v58, s53
  ds_add_u64 v56, v[52:53] offset:32
  v_dot2_f32_bf16 v55, v35, v57, s53
  v_dot2_f32_bf16 v54, v35, v58, s53
  ds_add_u64 v56, v[54:55] offset:48
  v_mov_b32_dpp v60, v47 quad_perm:[1,1,3,3] row_mask:0xf bank_mask:0xf
  v_add_u32_dpp v59, v43, v1 quad_perm:[1,1,3,3] row_mask:0xf bank_mask:0xf
  v_lshrrev_b32 v61, 16, v60
  v_dot2_f32_bf16 v49, v36, v60, s53
  v_dot2_f32_bf16 v48, v36, v61, s53
  ds_add_u64 v59, v[48:49] offset:0
  v_dot2_f32_bf16 v51, v37, v60, s53
  v_dot2_f32_bf16 v50, v37, v61, s53
  ds_add_u64 v59, v[50:51] offset:16
  v_dot2_f32_bf16 v53, v38, v60, s53
  v_dot2_f32_bf16 v52, v38, v61, s53
  ds_add_u64 v59, v[52:53] offset:32
  v_dot2_f32_bf16 v55, v39, v60, s53
  v_dot2_f32_bf16 v54, v39, v61, s53
  ds_add_u64 v59, v[54:55] offset:48
  s_cmp_eq_u32 s61, 0
  s_cbranch_scc1 LB_epi
LB_generic:
  s_waitcnt vmcnt(0)
  v_and_b32 v57, 63, v0
  v_lshrrev_b32 v56, 4, v57
  s_lshl_b32 s80, s50, 4
  v_add_u32 v57, s80, v56
  s_lshl_b32 s81, s2, 2
  v_lshlrev_b32 v58, 10, v57
  v_add_u32 v58, s81, v58
  v_add_u32 v59, 0, v58
  buffer_load_dwordx2 v[8:9], v59, s[16:19], 0 offen
  v_add_u32 v59, 4096, v58
  buffer_load_dwordx2 v[10:11], v59, s[16:19], 0 offen
  v_add_u32 v59, 8192, v58
  buffer_load_dwordx2 v[12:13], v59, s[16:19], 0 offen
  v_add_u32 v59, 12288, v58
  buffer_load_dwordx2 v[14:15], v59, s[16:19], 0 offen
  s_waitcnt vmcnt(0)
  s_mov_b32 s80, 25024
  v_add_u32 v59, 0, v57
  v_mad_u32_u24 v59, v59, s80, 1
  v_add_u32 v65, v59, v8
  s_cmp_eq_u32 s2, 255
  s_cbranch_scc0 LB_rp2_0
  v_add_u32 v60, 0, v57
  v_cmp_gt_u32 vcc, 160, v60
  v_mov_b32 v60, 25024
  v_mov_b32 v9, 24960
  v_cndmask_b32 v9, v9, v60, vcc
LB_rp2_0:
  v_sub_u32 v69, v9, v8
  v_add_u32 v59, 4, v57
  v_mad_u32_u24 v59, v59, s80, 1
  v_add_u32 v66, v59, v10
  s_cmp_eq_u32 s2, 255
  s_cbranch_scc0 LB_rp2_1
  v_add_u32 v60, 4, v57
  v_cmp_gt_u32 vcc, 160, v60
  v_mov_b32 v60, 25024
  v_mov_b32 v11, 24960
  v_cndmask_b32 v11, v11, v60, vcc
LB_rp2_1:
  v_sub_u32 v70, v11, v10
  v_add_u32 v59, 8, v57
  v_mad_u32_u24 v59, v59, s80, 1
  v_add_u32 v67, v59, v12
  s_cmp_eq_u32 s2, 255
  s_cbranch_scc0 LB_rp2_2
  v_add_u32 v60, 8, v57
  v_cmp_gt_u32 vcc, 160, v60
  v_mov_b32 v60, 25024
  v_mov_b32 v13, 24960
  v_cndmask_b32 v13, v13, v60, vcc
LB_rp2_2:
  v_sub_u32 v71, v13, v12
  v_add_u32 v59, 12, v57
  v_mad_u32_u24 v59, v59, s80, 1
  v_add_u32 v68, v59, v14
  s_cmp_eq_u32 s2, 255
  s_cbranch_scc0 LB_rp2_3
  v_add_u32 v60, 12, v57
  v_cmp_gt_u32 vcc, 160, v60
  v_mov_b32 v60, 25024
  v_mov_b32 v15, 24960
  v_cndmask_b32 v15, v15, v60, vcc
LB_rp2_3:
  v_sub_u32 v72, v15, v14
  v_min_u32 v73, 0x90, v69
  s_cmp_eq_u32 s56, 2
  s_cbranch_scc0 LB_gen0_c
  v_mov_b32 v73, 0
LB_gen0_c:
  v_min_u32 v74, 0x90, v70
  s_cmp_eq_u32 s56, 2
  s_cbranch_scc0 LB_gen1_c
  v_mov_b32 v74, 0
LB_gen1_c:
  v_min_u32 v75, 0x90, v71
  s_cmp_eq_u32 s56, 2
  s_cbranch_scc0 LB_gen2_c
  v_mov_b32 v75, 0
LB_gen2_c:
  v_min_u32 v76, 0x90, v72
  s_cmp_eq_u32 s56, 2
  s_cbranch_scc0 LB_gen3_c
  v_mov_b32 v76, 0
LB_gen3_c:
LB_gen0:
  v_add_u32 v56, v73, v77
  v_cmp_lt_u32 vcc, v56, v69
  s_cbranch_vccz LB_gen0_done
  v_add_u32 v56, v65, v56
  v_add_u32 v73, 16, v73
  v_cndmask_b32 v56, -1, v56, vcc
  buffer_load_dword v16, v56, s[4:7], 0 idxen
  buffer_load_ushort v17, v56, s[8:11], 0 idxen
  s_waitcnt vmcnt(0)
  v_bfi_b32 v62, v16, 0, s57
  v_bfe_u32 v63, v16, 19, 11
  v_lshlrev_b32 v64, 16, v17
  v_mad_i32_i24 v40, v63, s58, v6
  v_mul_f32 v44, s54, v64
  ds_add_u32 v40, v7 offset:64
  v_mov_b32_dpp v2, v62 quad_perm:[0,0,2,2] row_mask:0xf bank_mask:0xf
  buffer_load_dwordx4 v[8:11], v[2:3], s[12:15], 0 idxen offen
  v_mov_b32_dpp v4, v62 quad_perm:[1,1,3,3] row_mask:0xf bank_mask:0xf
  buffer_load_dwordx4 v[12:15], v[4:5], s[12:15], 0 idxen offen
  s_waitcnt vmcnt(0)
  s_cmp_eq_u32 s56, 2
  s_cbranch_scc1 LB_gen0_f
  v_mov_b32_dpp v57, v44 quad_perm:[0,0,2,2] row_mask:0xf bank_mask:0xf
  v_add_u32_dpp v56, v40, v1 quad_perm:[0,0,2,2] row_mask:0xf bank_mask:0xf
  v_lshrrev_b32 v58, 16, v57
  v_dot2_f32_bf16 v49, v8, v57, s53
  v_dot2_f32_bf16 v48, v8, v58, s53
  ds_add_u64 v56, v[48:49] offset:0
  v_dot2_f32_bf16 v51, v9, v57, s53
  v_dot2_f32_bf16 v50, v9, v58, s53
  ds_add_u64 v56, v[50:51] offset:16
  v_dot2_f32_bf16 v53, v10, v57, s53
  v_dot2_f32_bf16 v52, v10, v58, s53
  ds_add_u64 v56, v[52:53] offset:32
  v_dot2_f32_bf16 v55, v11, v57, s53
  v_dot2_f32_bf16 v54, v11, v58, s53
  ds_add_u64 v56, v[54:55] offset:48
  v_mov_b32_dpp v60, v44 quad_perm:[1,1,3,3] row_mask:0xf bank_mask:0xf
  v_add_u32_dpp v59, v40, v1 quad_perm:[1,1,3,3] row_mask:0xf bank_mask:0xf
  v_lshrrev_b32 v61, 16, v60
  v_dot2_f32_bf16 v49, v12, v60, s53
  v_dot2_f32_bf16 v48, v12, v61, s53
  ds_add_u64 v59, v[48:49] offset:0
  v_dot2_f32_bf16 v51, v13, v60, s53
  v_dot2_f32_bf16 v50, v13, v61, s53
  ds_add_u64 v59, v[50:51] offset:16
  v_dot2_f32_bf16 v53, v14, v60, s53
  v_dot2_f32_bf16 v52, v14, v61, s53
  ds_add_u64 v59, v[52:53] offset:32
  v_dot2_f32_bf16 v55, v15, v60, s53
  v_dot2_f32_bf16 v54, v15, v61, s53
  ds_add_u64 v59, v[54:55] offset:48
  s_branch LB_gen0
LB_gen0_f:
  v_mov_b32_dpp v57, v44 quad_perm:[0,0,2,2] row_mask:0xf bank_mask:0xf
  v_add_u32_dpp v56, v40, v1 quad_perm:[0,0,2,2] row_mask:0xf bank_mask:0xf
  v_lshrrev_b32 v58, 16, v57
  v_dot2_f32_bf16 v49, v8, v57, s53
  v_dot2_f32_bf16 v48, v8, v58, s53
  ds_add_f32 v56, v48 offset:0
  ds_add_f32 v56, v49 offset:4
  v_dot2_f32_bf16 v51, v9, v57, s53
  v_dot2_f32_bf16 v50, v9, v58, s53
  ds_add_f32 v56, v50 offset:16
  ds_add_f32 v56, v51 offset:20
  v_dot2_f32_bf16 v53, v10, v57, s53
  v_dot2_f32_bf16 v52, v10, v58, s53
  ds_add_f32 v56, v52 offset:32
  ds_add_f32 v56, v53 offset:36
  v_dot2_f32_bf16 v55, v11, v57, s53
  v_dot2_f32_bf16 v54, v11, v58, s53
  ds_add_f32 v56, v54 offset:48
  ds_add_f32 v56, v55 offset:52
  v_mov_b32_dpp v60, v44 quad_perm:[1,1,3,3] row_mask:0xf bank_mask:0xf
  v_add_u32_dpp v59, v40, v1 quad_perm:[1,1,3,3] row_mask:0xf bank_mask:0xf
  v_lshrrev_b32 v61, 16, v60
  v_dot2_f32_bf16 v49, v12, v60, s53
  v_dot2_f32_bf16 v48, v12, v61, s53
  ds_add_f32 v59, v48 offset:0
  ds_add_f32 v59, v49 offset:4
  v_dot2_f32_bf16 v51, v13, v60, s53
  v_dot2_f32_bf16 v50, v13, v61, s53
  ds_add_f32 v59, v50 offset:16
  ds_add_f32 v59, v51 offset:20
  v_dot2_f32_bf16 v53, v14, v60, s53
  v_dot2_f32_bf16 v52, v14, v61, s53
  ds_add_f32 v59, v52 offset:32
  ds_add_f32 v59, v53 offset:36
  v_dot2_f32_bf16 v55, v15, v60, s53
  v_dot2_f32_bf16 v54, v15, v61, s53
  ds_add_f32 v59, v54 offset:48
  ds_add_f32 v59, v55 offset:52
  s_branch LB_gen0
LB_gen0_done:
LB_gen1:
  v_add_u32 v56, v74, v77
  v_cmp_lt_u32 vcc, v56, v70
  s_cbranch_vccz LB_gen1_done
  v_add_u32 v56, v66, v56
  v_add_u32 v74, 16, v74
  v_cndmask_b32 v56, -1, v56, vcc
  buffer_load_dword v16, v56, s[4:7], 0 idxen
  buffer_load_ushort v17, v56, s[8:11], 0 idxen
  s_waitcnt vmcnt(0)
  v_bfi_b32 v62, v16, 0, s57
  v_bfe_u32 v63, v16, 19, 11
  v_lshlrev_b32 v64, 16, v17
  v_mad_i32_i24 v40, v63, s58, v6
  v_mul_f32 v44, s54, v64
  ds_add_u32 v40, v7 offset:64
  v_mov_b32_dpp v2, v62 quad_perm:[0,0,2,2] row_mask:0xf bank_mask:0xf
  buffer_load_dwordx4 v[8:11], v[2:3], s[12:15], 0 idxen offen
  v_mov_b32_dpp v4, v62 quad_perm:[1,1,3,3] row_mask:0xf bank_mask:0xf
  buffer_load_dwordx4 v[12:15], v[4:5], s[12:15], 0 idxen offen
  s_waitcnt vmcnt(0)
  s_cmp_eq_u32 s56, 2
  s_cbranch_scc1 LB_gen1_f
  v_mov_b32_dpp v57, v44 quad_perm:[0,0,2,2] row_mask:0xf bank_mask:0xf
  v_add_u32_dpp v56, v40, v1 quad_perm:[0,0,2,2] row_mask:0xf bank_mask:0xf
  v_lshrrev_b32 v58, 16, v57
  v_dot2_f32_bf16 v49, v8, v57, s53
  v_dot2_f32_bf16 v48, v8, v58, s53
  ds_add_u64 v56, v[48:49] offset:0
  v_dot2_f32_bf16 v51, v9, v57, s53
  v_dot2_f32_bf16 v50, v9, v58, s53
  ds_add_u64 v56, v[50:51] offset:16
  v_dot2_f32_bf16 v53, v10, v57, s53
  v_dot2_f32_bf16 v52, v10, v58, s53
  ds_add_u64 v56, v[52:53] offset:32
  v_dot2_f32_bf16 v55, v11, v57, s53
  v_dot2_f32_bf16 v54, v11, v58, s53
  ds_add_u64 v56, v[54:55] offset:48
  v_mov_b32_dpp v60, v44 quad_perm:[1,1,3,3] row_mask:0xf bank_mask:0xf
  v_add_u32_dpp v59, v40, v1 quad_perm:[1,1,3,3] row_mask:0xf bank_mask:0xf
  v_lshrrev_b32 v61, 16, v60
  v_dot2_f32_bf16 v49, v12, v60, s53
  v_dot2_f32_bf16 v48, v12, v61, s53
  ds_add_u64 v59, v[48:49] offset:0
  v_dot2_f32_bf16 v51, v13, v60, s53
  v_dot2_f32_bf16 v50, v13, v61, s53
  ds_add_u64 v59, v[50:51] offset:16
  v_dot2_f32_bf16 v53, v14, v60, s53
  v_dot2_f32_bf16 v52, v14, v61, s53
  ds_add_u64 v59, v[52:53] offset:32
  v_dot2_f32_bf16 v55, v15, v60, s53
  v_dot2_f32_bf16 v54, v15, v61, s53
  ds_add_u64 v59, v[54:55] offset:48
  s_branch LB_gen1
LB_gen1_f:
  v_mov_b32_dpp v57, v44 quad_perm:[0,0,2,2] row_mask:0xf bank_mask:0xf
  v_add_u32_dpp v56, v40, v1 quad_perm:[0,0,2,2] row_mask:0xf bank_mask:0xf
  v_lshrrev_b32 v58, 16, v57
  v_dot2_f32_bf16 v49, v8, v57, s53
  v_dot2_f32_bf16 v48, v8, v58, s53
  ds_add_f32 v56, v48 offset:0
  ds_add_f32 v56, v49 offset:4
  v_dot2_f32_bf16 v51, v9, v57, s53
  v_dot2_f32_bf16 v50, v9, v58, s53
  ds_add_f32 v56, v50 offset:16
  ds_add_f32 v56, v51 offset:20
  v_dot2_f32_bf16 v53, v10, v57, s53
  v_dot2_f32_bf16 v52, v10, v58, s53
  ds_add_f32 v56, v52 offset:32
  ds_add_f32 v56, v53 offset:36
  v_dot2_f32_bf16 v55, v11, v57, s53
  v_dot2_f32_bf16 v54, v11, v58, s53
  ds_add_f32 v56, v54 offset:48
  ds_add_f32 v56, v55 offset:52
  v_mov_b32_dpp v60, v44 quad_perm:[1,1,3,3] row_mask:0xf bank_mask:0xf
  v_add_u32_dpp v59, v40, v1 quad_perm:[1,1,3,3] row_mask:0xf bank_mask:0xf
  v_lshrrev_b32 v61, 16, v60
  v_dot2_f32_bf16 v49, v12, v60, s53
  v_dot2_f32_bf16 v48, v12, v61, s53
  ds_add_f32 v59, v48 offset:0
  ds_add_f32 v59, v49 offset:4
  v_dot2_f32_bf16 v51, v13, v60, s53
  v_dot2_f32_bf16 v50, v13, v61, s53
  ds_add_f32 v59, v50 offset:16
  ds_add_f32 v59, v51 offset:20
  v_dot2_f32_bf16 v53, v14, v60, s53
  v_dot2_f32_bf16 v52, v14, v61, s53
  ds_add_f32 v59, v52 offset:32
  ds_add_f32 v59, v53 offset:36
  v_dot2_f32_bf16 v55, v15, v60, s53
  v_dot2_f32_bf16 v54, v15, v61, s53
  ds_add_f32 v59, v54 offset:48
  ds_add_f32 v59, v55 offset:52
  s_branch LB_gen1
LB_gen1_done:
LB_gen2:
  v_add_u32 v56, v75, v77
  v_cmp_lt_u32 vcc, v56, v71
  s_cbranch_vccz LB_gen2_done
  v_add_u32 v56, v67, v56
  v_add_u32 v75, 16, v75
  v_cndmask_b32 v56, -1, v56, vcc
  buffer_load_dword v16, v56, s[4:7], 0 idxen
  buffer_load_ushort v17, v56, s[8:11], 0 idxen
  s_waitcnt vmcnt(0)
  v_bfi_b32 v62, v16, 0, s57
  v_bfe_u32 v63, v16, 19, 11
  v_lshlrev_b32 v64, 16, v17
  v_mad_i32_i24 v40, v63, s58, v6
  v_mul_f32 v44, s54, v64
  ds_add_u32 v40, v7 offset:64
  v_mov_b32_dpp v2, v62 quad_perm:[0,0,2,2] row_mask:0xf bank_mask:0xf
  buffer_load_dwordx4 v[8:11], v[2:3], s[12:15], 0 idxen offen
  v_mov_b32_dpp v4, v62 quad_perm:[1,1,3,3] row_mask:0xf bank_mask:0xf
  buffer_load_dwordx4 v[12:15], v[4:5], s[12:15], 0 idxen offen
  s_waitcnt vmcnt(0)
  s_cmp_eq_u32 s56, 2
  s_cbranch_scc1 LB_gen2_f
  v_mov_b32_dpp v57, v44 quad_perm:[0,0,2,2] row_mask:0xf bank_mask:0xf
  v_add_u32_dpp v56, v40, v1 quad_perm:[0,0,2,2] row_mask:0xf bank_mask:0xf
  v_lshrrev_b32 v58, 16, v57
  v_dot2_f32_bf16 v49, v8, v57, s53
  v_dot2_f32_bf16 v48, v8, v58, s53
  ds_add_u64 v56, v[48:49] offset:0
  v_dot2_f32_bf16 v51, v9, v57, s53
  v_dot2_f32_bf16 v50, v9, v58, s53
  ds_add_u64 v56, v[50:51] offset:16
  v_dot2_f32_bf16 v53, v10, v57, s53
  v_dot2_f32_bf16 v52, v10, v58, s53
  ds_add_u64 v56, v[52:53] offset:32
  v_dot2_f32_bf16 v55, v11, v57, s53
  v_dot2_f32_bf16 v54, v11, v58, s53
  ds_add_u64 v56, v[54:55] offset:48
  v_mov_b32_dpp v60, v44 quad_perm:[1,1,3,3] row_mask:0xf bank_mask:0xf
  v_add_u32_dpp v59, v40, v1 quad_perm:[1,1,3,3] row_mask:0xf bank_mask:0xf
  v_lshrrev_b32 v61, 16, v60
  v_dot2_f32_bf16 v49, v12, v60, s53
  v_dot2_f32_bf16 v48, v12, v61, s53
  ds_add_u64 v59, v[48:49] offset:0
  v_dot2_f32_bf16 v51, v13, v60, s53
  v_dot2_f32_bf16 v50, v13, v61, s53
  ds_add_u64 v59, v[50:51] offset:16
  v_dot2_f32_bf16 v53, v14, v60, s53
  v_dot2_f32_bf16 v52, v14, v61, s53
  ds_add_u64 v59, v[52:53] offset:32
  v_dot2_f32_bf16 v55, v15, v60, s53
  v_dot2_f32_bf16 v54, v15, v61, s53
  ds_add_u64 v59, v[54:55] offset:48
  s_branch LB_gen2
LB_gen2_f:
  v_mov_b32_dpp v57, v44 quad_perm:[0,0,2,2] row_mask:0xf bank_mask:0xf
  v_add_u32_dpp v56, v40, v1 quad_perm:[0,0,2,2] row_mask:0xf bank_mask:0xf
  v_lshrrev_b32 v58, 16, v57
  v_dot2_f32_bf16 v49, v8, v57, s53
  v_dot2_f32_bf16 v48, v8, v58, s53
  ds_add_f32 v56, v48 offset:0
  ds_add_f32 v56, v49 offset:4
  v_dot2_f32_bf16 v51, v9, v57, s53
  v_dot2_f32_bf16 v50, v9, v58, s53
  ds_add_f32 v56, v50 offset:16
  ds_add_f32 v56, v51 offset:20
  v_dot2_f32_bf16 v53, v10, v57, s53
  v_dot2_f32_bf16 v52, v10, v58, s53
  ds_add_f32 v56, v52 offset:32
  ds_add_f32 v56, v53 offset:36
  v_dot2_f32_bf16 v55, v11, v57, s53
  v_dot2_f32_bf16 v54, v11, v58, s53
  ds_add_f32 v56, v54 offset:48
  ds_add_f32 v56, v55 offset:52
  v_mov_b32_dpp v60, v44 quad_perm:[1,1,3,3] row_mask:0xf bank_mask:0xf
  v_add_u32_dpp v59, v40, v1 quad_perm:[1,1,3,3] row_mask:0xf bank_mask:0xf
  v_lshrrev_b32 v61, 16, v60
  v_dot2_f32_bf16 v49, v12, v60, s53
  v_dot2_f32_bf16 v48, v12, v61, s53
  ds_add_f32 v59, v48 offset:0
  ds_add_f32 v59, v49 offset:4
  v_dot2_f32_bf16 v51, v13, v60, s53
  v_dot2_f32_bf16 v50, v13, v61, s53
  ds_add_f32 v59, v50 offset:16
  ds_add_f32 v59, v51 offset:20
  v_dot2_f32_bf16 v53, v14, v60, s53
  v_dot2_f32_bf16 v52, v14, v61, s53
  ds_add_f32 v59, v52 offset:32
  ds_add_f32 v59, v53 offset:36
  v_dot2_f32_bf16 v55, v15, v60, s53
  v_dot2_f32_bf16 v54, v15, v61, s53
  ds_add_f32 v59, v54 offset:48
  ds_add_f32 v59, v55 offset:52
  s_branch LB_gen2
LB_gen2_done:
LB_gen3:
  v_add_u32 v56, v76, v77
  v_cmp_lt_u32 vcc, v56, v72
  s_cbranch_vccz LB_gen3_done
  v_add_u32 v56, v68, v56
  v_add_u32 v76, 16, v76
  v_cndmask_b32 v56, -1, v56, vcc
  buffer_load_dword v16, v56, s[4:7], 0 idxen
  buffer_load_ushort v17, v56, s[8:11], 0 idxen
  s_waitcnt vmcnt(0)
  v_bfi_b32 v62, v16, 0, s57
  v_bfe_u32 v63, v16, 19, 11
  v_lshlrev_b32 v64, 16, v17
  v_mad_i32_i24 v40, v63, s58, v6
  v_mul_f32 v44, s54, v64
  ds_add_u32 v40, v7 offset:64
  v_mov_b32_dpp v2, v62 quad_perm:[0,0,2,2] row_mask:0xf bank_mask:0xf
  buffer_load_dwordx4 v[8:11], v[2:3], s[12:15], 0 idxen offen
  v_mov_b32_dpp v4, v62 quad_perm:[1,1,3,3] row_mask:0xf bank_mask:0xf
  buffer_load_dwordx4 v[12:15], v[4:5], s[12:15], 0 idxen offen
  s_waitcnt vmcnt(0)
  s_cmp_eq_u32 s56, 2
  s_cbranch_scc1 LB_gen3_f
  v_mov_b32_dpp v57, v44 quad_perm:[0,0,2,2] row_mask:0xf bank_mask:0xf
  v_add_u32_dpp v56, v40, v1 quad_perm:[0,0,2,2] row_mask:0xf bank_mask:0xf
  v_lshrrev_b32 v58, 16, v57
  v_dot2_f32_bf16 v49, v8, v57, s53
  v_dot2_f32_bf16 v48, v8, v58, s53
  ds_add_u64 v56, v[48:49] offset:0
  v_dot2_f32_bf16 v51, v9, v57, s53
  v_dot2_f32_bf16 v50, v9, v58, s53
  ds_add_u64 v56, v[50:51] offset:16
  v_dot2_f32_bf16 v53, v10, v57, s53
  v_dot2_f32_bf16 v52, v10, v58, s53
  ds_add_u64 v56, v[52:53] offset:32
  v_dot2_f32_bf16 v55, v11, v57, s53
  v_dot2_f32_bf16 v54, v11, v58, s53
  ds_add_u64 v56, v[54:55] offset:48
  v_mov_b32_dpp v60, v44 quad_perm:[1,1,3,3] row_mask:0xf bank_mask:0xf
  v_add_u32_dpp v59, v40, v1 quad_perm:[1,1,3,3] row_mask:0xf bank_mask:0xf
  v_lshrrev_b32 v61, 16, v60
  v_dot2_f32_bf16 v49, v12, v60, s53
  v_dot2_f32_bf16 v48, v12, v61, s53
  ds_add_u64 v59, v[48:49] offset:0
  v_dot2_f32_bf16 v51, v13, v60, s53
  v_dot2_f32_bf16 v50, v13, v61, s53
  ds_add_u64 v59, v[50:51] offset:16
  v_dot2_f32_bf16 v53, v14, v60, s53
  v_dot2_f32_bf16 v52, v14, v61, s53
  ds_add_u64 v59, v[52:53] offset:32
  v_dot2_f32_bf16 v55, v15, v60, s53
  v_dot2_f32_bf16 v54, v15, v61, s53
  ds_add_u64 v59, v[54:55] offset:48
  s_branch LB_gen3
LB_gen3_f:
  v_mov_b32_dpp v57, v44 quad_perm:[0,0,2,2] row_mask:0xf bank_mask:0xf
  v_add_u32_dpp v56, v40, v1 quad_perm:[0,0,2,2] row_mask:0xf bank_mask:0xf
  v_lshrrev_b32 v58, 16, v57
  v_dot2_f32_bf16 v49, v8, v57, s53
  v_dot2_f32_bf16 v48, v8, v58, s53
  ds_add_f32 v56, v48 offset:0
  ds_add_f32 v56, v49 offset:4
  v_dot2_f32_bf16 v51, v9, v57, s53
  v_dot2_f32_bf16 v50, v9, v58, s53
  ds_add_f32 v56, v50 offset:16
  ds_add_f32 v56, v51 offset:20
  v_dot2_f32_bf16 v53, v10, v57, s53
  v_dot2_f32_bf16 v52, v10, v58, s53
  ds_add_f32 v56, v52 offset:32
  ds_add_f32 v56, v53 offset:36
  v_dot2_f32_bf16 v55, v11, v57, s53
  v_dot2_f32_bf16 v54, v11, v58, s53
  ds_add_f32 v56, v54 offset:48
  ds_add_f32 v56, v55 offset:52
  v_mov_b32_dpp v60, v44 quad_perm:[1,1,3,3] row_mask:0xf bank_mask:0xf
  v_add_u32_dpp v59, v40, v1 quad_perm:[1,1,3,3] row_mask:0xf bank_mask:0xf
  v_lshrrev_b32 v61, 16, v60
  v_dot2_f32_bf16 v49, v12, v60, s53
  v_dot2_f32_bf16 v48, v12, v61, s53
  ds_add_f32 v59, v48 offset:0
  ds_add_f32 v59, v49 offset:4
  v_dot2_f32_bf16 v51, v13, v60, s53
  v_dot2_f32_bf16 v50, v13, v61, s53
  ds_add_f32 v59, v50 offset:16
  ds_add_f32 v59, v51 offset:20
  v_dot2_f32_bf16 v53, v14, v60, s53
  v_dot2_f32_bf16 v52, v14, v61, s53
  ds_add_f32 v59, v52 offset:32
  ds_add_f32 v59, v53 offset:36
  v_dot2_f32_bf16 v55, v15, v60, s53
  v_dot2_f32_bf16 v54, v15, v61, s53
  ds_add_f32 v59, v54 offset:48
  ds_add_f32 v59, v55 offset:52
  s_branch LB_gen3
LB_gen3_done:
  s_cmp_eq_u32 s56, 2
  s_cbranch_scc0 LB_epi
  v_and_b32 v64, 63, v0
  v_lshrrev_b32 v63, 4, v64
  v_lshlrev_b32 v64, 6, v63
  v_lshl_add_u32 v64, v77, 1, v64
  global_load_ushort v80, v64, s[72:73] offset:0
  global_load_ushort v110, v64, s[72:73] offset:32
  global_load_ushort v81, v64, s[72:73] offset:256
  global_load_ushort v111, v64, s[72:73] offset:288
  global_load_ushort v86, v64, s[44:45] offset:0
  global_load_ushort v84, v64, s[46:47] offset:0
  global_load_ushort v114, v64, s[44:45] offset:32
  global_load_ushort v115, v64, s[46:47] offset:32
  v_lshlrev_b32 v64, 7, v63
  v_lshl_add_u32 v64, v77, 1, v64
  global_load_ushort v82, v64, s[74:75] offset:0
  global_load_ushort v112, v64, s[74:75] offset:32
  global_load_ushort v83, v64, s[74:75] offset:64
  global_load_ushort v113, v64, s[74:75] offset:96
  v_lshlrev_b32 v64, 2, v63
  global_load_dword v70, v64, s[40:41]
  s_lshl_b32 s80, s50, 5
  v_lshl_add_u32 v64, v77, 1, s80
  buffer_load_ushort v96, v64, s[32:35], 0 offen offset:0
  v_mov_b32 v97, 0
  buffer_load_ushort v98, v64, s[32:35], 0 offen offset:512
  v_mov_b32 v99, 0
  buffer_load_ushort v100, v64, s[32:35], 0 offen offset:1024
  v_mov_b32 v101, 0
  buffer_load_ushort v102, v64, s[32:35], 0 offen offset:1536
  v_mov_b32 v103, 0
  buffer_load_ushort v104, v64, s[32:35], 0 offen offset:2048
  v_mov_b32 v105, 0
  buffer_load_ushort v106, v64, s[32:35], 0 offen offset:2560
  v_mov_b32 v107, 0
  buffer_load_ushort v108, v64, s[32:35], 0 offen offset:3072
  v_mov_b32 v109, 0
  s_waitcnt vmcnt(0)
  v_lshl_or_b32 v80, v110, 16, v80
  v_lshl_or_b32 v81, v111, 16, v81
  v_lshl_or_b32 v82, v112, 16, v82
  v_lshl_or_b32 v83, v113, 16, v83
  v_lshl_or_b32 v86, v114, 16, v86
  v_lshl_or_b32 v84, v115, 16, v84
  v_mov_b32 v87, 0
  v_mov_b32 v85, 0
  v_lshlrev_b32 v67, 16, v80
  v_and_b32 v68, 0xffff0000, v80
  v_mul_f32 v67, s55, v67
  v_mul_f32 v68, s55, v68
  v_cvt_pk_bf16_f32 v78, v67, v68
  v_lshlrev_b32 v67, 16, v81
  v_and_b32 v68, 0xffff0000, v81
  v_mul_f32 v67, s55, v67
  v_mul_f32 v68, s55, v68
  v_cvt_pk_bf16_f32 v79, v67, v68
  v_lshlrev_b32 v65, 16, v70
  v_and_b32 v66, 0xffff0000, v70
  s_mov_b32 s80, 0xc1200000
  s_mov_b32 s81, 0x3fb8aa3b
  v_lshlrev_b32 v96, 16, v96
  v_sub_f32 v67, v96, v65
  v_sub_f32 v68, v96, v66
  v_cvt_pk_bf16_f32 v69, v67, v68
  v_lshlrev_b32 v67, 16, v69
  v_and_b32 v68, 0xffff0000, v69
  v_mul_f32 v67, v67, v67
  v_mul_f32 v68, v68, v68
  v_cvt_pk_bf16_f32 v69, v67, v68
  v_lshlrev_b32 v67, 16, v69
  v_and_b32 v68, 0xffff0000, v69
  v_mul_f32 v67, s80, v67
  v_mul_f32 v68, s80, v68
  v_cvt_pk_bf16_f32 v69, v67, v68
  v_lshlrev_b32 v67, 16, v69
  v_and_b32 v68, 0xffff0000, v69
  v_mul_f32 v67, s81, v67
  v_mul_f32 v68, s81, v68
  v_exp_f32 v67, v67
  v_exp_f32 v68, v68
  s_nop 0
  v_cvt_pk_bf16_f32 v96, v67, v68
  s_mov_b32 s80, 0xc1200000
  s_mov_b32 s81, 0x3fb8aa3b
  v_lshlrev_b32 v98, 16, v98
  v_sub_f32 v67, v98, v65
  v_sub_f32 v68, v98, v66
  v_cvt_pk_bf16_f32 v69, v67, v68
  v_lshlrev_b32 v67, 16, v69
  v_and_b32 v68, 0xffff0000, v69
  v_mul_f32 v67, v67, v67
  v_mul_f32 v68, v68, v68
  v_cvt_pk_bf16_f32 v69, v67, v68
  v_lshlrev_b32 v67, 16, v69
  v_and_b32 v68, 0xffff0000, v69
  v_mul_f32 v67, s80, v67
  v_mul_f32 v68, s80, v68
  v_cvt_pk_bf16_f32 v69, v67, v68
  v_lshlrev_b32 v67, 16, v69
  v_and_b32 v68, 0xffff0000, v69
  v_mul_f32 v67, s81, v67
  v_mul_f32 v68, s81, v68
  v_exp_f32 v67, v67
  v_exp_f32 v68, v68
  s_nop 0
  v_cvt_pk_bf16_f32 v98, v67, v68
  s_mov_b32 s80, 0xc1200000
  s_mov_b32 s81, 0x3fb8aa3b
  v_lshlrev_b32 v100, 16, v100
  v_sub_f32 v67, v100, v65
  v_sub_f32 v68, v100, v66
  v_cvt_pk_bf16_f32 v69, v67, v68
  v_lshlrev_b32 v67, 16, v69
  v_and_b32 v68, 0xffff0000, v69
  v_mul_f32 v67, v67, v67
  v_mul_f32 v68, v68, v68
  v_cvt_pk_bf16_f32 v69, v67, v68
  v_lshlrev_b32 v67, 16, v69
  v_and_b32 v68, 0xffff0000, v69
  v_mul_f32 v67, s80, v67
  v_mul_f32 v68, s80, v68
  v_cvt_pk_bf16_f32 v69, v67, v68
  v_lshlrev_b32 v67, 16, v69
  v_and_b32 v68, 0xffff0000, v69
  v_mul_f32 v67, s81, v67
  v_mul_f32 v68, s81, v68
  v_exp_f32 v67, v67
  v_exp_f32 v68, v68
  s_nop 0
  v_cvt_pk_bf16_f32 v100, v67, v68
  s_mov_b32 s80, 0xc1200000
  s_mov_b32 s81, 0x3fb8aa3b
  v_lshlrev_b32 v102, 16, v102
  v_sub_f32 v67, v102, v65
  v_sub_f32 v68, v102, v66
  v_cvt_pk_bf16_f32 v69, v67, v68
  v_lshlrev_b32 v67, 16, v69
  v_and_b32 v68, 0xffff0000, v69
  v_mul_f32 v67, v67, v67
  v_mul_f32 v68, v68, v68
  v_cvt_pk_bf16_f32 v69, v67, v68
  v_lshlrev_b32 v67, 16, v69
  v_and_b32 v68, 0xffff0000, v69
  v_mul_f32 v67, s80, v67
  v_mul_f32 v68, s80, v68
  v_cvt_pk_bf16_f32 v69, v67, v68
  v_lshlrev_b32 v67, 16, v69
  v_and_b32 v68, 0xffff0000, v69
  v_mul_f32 v67, s81, v67
  v_mul_f32 v68, s81, v68
  v_exp_f32 v67, v67
  v_exp_f32 v68, v68
  s_nop 0
  v_cvt_pk_bf16_f32 v102, v67, v68
  s_mov_b32 s80, 0xc1200000
  s_mov_b32 s81, 0x3fb8aa3b
  v_lshlrev_b32 v104, 16, v104
  v_sub_f32 v67, v104, v65
  v_sub_f32 v68, v104, v66
  v_cvt_pk_bf16_f32 v69, v67, v68
  v_lshlrev_b32 v67, 16, v69
  v_and_b32 v68, 0xffff0000, v69
  v_mul_f32 v67, v67, v67
  v_mul_f32 v68, v68, v68
  v_cvt_pk_bf16_f32 v69, v67, v68
  v_lshlrev_b32 v67, 16, v69
  v_and_b32 v68, 0xffff0000, v69
  v_mul_f32 v67, s80, v67
  v_mul_f32 v68, s80, v68
  v_cvt_pk_bf16_f32 v69, v67, v68
  v_lshlrev_b32 v67, 16, v69
  v_and_b32 v68, 0xffff0000, v69
  v_mul_f32 v67, s81, v67
  v_mul_f32 v68, s81, v68
  v_exp_f32 v67, v67
  v_exp_f32 v68, v68
  s_nop 0
  v_cvt_pk_bf16_f32 v104, v67, v68
  s_mov_b32 s80, 0xc1200000
  s_mov_b32 s81, 0x3fb8aa3b
  v_lshlrev_b32 v106, 16, v106
  v_sub_f32 v67, v106, v65
  v_sub_f32 v68, v106, v66
  v_cvt_pk_bf16_f32 v69, v67, v68
  v_lshlrev_b32 v67, 16, v69
  v_and_b32 v68, 0xffff0000, v69
  v_mul_f32 v67, v67, v67
  v_mul_f32 v68, v68, v68
  v_cvt_pk_bf16_f32 v69, v67, v68
  v_lshlrev_b32 v67, 16, v69
  v_and_b32 v68, 0xffff0000, v69
  v_mul_f32 v67, s80, v67
  v_mul_f32 v68, s80, v68
  v_cvt_pk_bf16_f32 v69, v67, v68
  v_lshlrev_b32 v67, 16, v69
  v_and_b32 v68, 0xffff0000, v69
  v_mul_f32 v67, s81, v67
  v_mul_f32 v68, s81, v68
  v_exp_f32 v67, v67
  v_exp_f32 v68, v68
  s_nop 0
  v_cvt_pk_bf16_f32 v106, v67, v68
  s_mov_b32 s80, 0xc1200000
  s_mov_b32 s81, 0x3fb8aa3b
  v_lshlrev_b32 v108, 16, v108
  v_sub_f32 v67, v108, v65
  v_sub_f32 v68, v108, v66
  v_cvt_pk_bf16_f32 v69, v67, v68
  v_lshlrev_b32 v67, 16, v69
  v_and_b32 v68, 0xffff0000, v69
  v_mul_f32 v67, v67, v67
  v_mul_f32 v68, v68, v68
  v_cvt_pk_bf16_f32 v69, v67, v68
  v_lshlrev_b32 v67, 16, v69
  v_and_b32 v68, 0xffff0000, v69
  v_mul_f32 v67, s80, v67
  v_mul_f32 v68, s80, v68
  v_cvt_pk_bf16_f32 v69, v67, v68
  v_lshlrev_b32 v67, 16, v69
  v_and_b32 v68, 0xffff0000, v69
  v_mul_f32 v67, s81, v67
  v_mul_f32 v68, s81, v68
  v_exp_f32 v67, v67
  v_exp_f32 v68, v68
  s_nop 0
  v_cvt_pk_bf16_f32 v108, v67, v68
  v_and_b32 v64, 63, v0
  v_lshrrev_b32 v63, 4, v64
  s_lshl_b32 s80, s50, 9
  v_lshlrev_b32 v64, 5, v77
  v_lshl_add_u32 v64, v63, 3, v64
  v_add_u32 v64, s80, v64
  s_mov_b32 s81, 0
  buffer_load_dwordx2 v[110:111], v64, s[24:27], s81 offen
  s_mov_b32 s81, 8192
  buffer_load_dwordx2 v[112:113], v64, s[24:27], s81 offen
  s_mov_b32 s81, 16384
  buffer_load_dwordx2 v[114:115], v64, s[24:27], s81 offen
  s_mov_b32 s81, 24576
  buffer_load_dwordx2 v[116:117], v64, s[24:27], s81 offen
  s_mov_b32 s81, 32768
  buffer_load_dwordx2 v[118:119], v64, s[24:27], s81 offen
  s_mov_b32 s81, 40960
  buffer_load_dwordx2 v[120:121], v64, s[24:27], s81 offen
  s_mov_b32 s81, 49152
  buffer_load_dwordx2 v[122:123], v64, s[24:27], s81 offen
LB_epi:
  s_waitcnt lgkmcnt(0)
  s_barrier
  v_and_b32 v57, 63, v0
  v_lshrrev_b32 v56, 4, v57
  s_lshl_b32 s80, s50, 4
  v_add_u32 v57, s80, v77
  v_mul_u32_u24 v57, 80, v57
  v_lshl_add_u32 v58, v56, 4, v57
  v_add_u32 v59, 81920, v57
  v_add_u32 v60, 81920, v58
  ds_read_b128 v[8:11], v58 offset:0
  ds_read_b32 v12, v57 offset:64
  ds_read_b128 v[20:23], v58 offset:20480
  ds_read_b32 v24, v57 offset:20544
  ds_read_b128 v[32:35], v58 offset:40960
  ds_read_b32 v36, v57 offset:41024
  ds_read_b128 v[44:47], v58 offset:61440
  ds_read_b32 v48, v57 offset:61504
  s_lshl_b32 s80, s50, 9
  v_lshlrev_b32 v62, 5, v77
  v_lshl_add_u32 v62, v56, 3, v62
  v_add_u32 v62, s80, v62
  v_mov_b32 v71, 0
  s_waitcnt lgkmcnt(0)
  s_cmp_eq_u32 s56, 2
  v_max_u32 v71, v71, v12
  s_cbranch_scc1 LB_e0_f
  v_mul_u32_u24 v12, 0x12d, v12
  v_lshlrev_b32 v13, 22, v12
  v_sub_u32 v8, v8, v13
  v_sub_u32 v9, v9, v13
  v_ashrrev_i32 v14, 22, v8
  v_add_u32 v14, v14, v12
  v_ashrrev_i32 v14, 10, v14
  v_sub_u32 v9, v9, v14
  v_sub_u32 v10, v10, v13
  v_sub_u32 v11, v11, v13
  v_ashrrev_i32 v14, 22, v10
  v_add_u32 v14, v14, v12
  v_ashrrev_i32 v14, 10, v14
  v_sub_u32 v11, v11, v14
  v_cvt_f32_i32 v8, v8
  v_cvt_f32_i32 v9, v9
  v_cvt_f32_i32 v10, v10
  v_cvt_f32_i32 v11, v11
LB_e0_f:
  v_cvt_pk_bf16_f32 v66, v8, v9
  v_cvt_pk_bf16_f32 v67, v10, v11
  v_mfma_f32_16x16x16_bf16 v[12:15], v[84:85], v[96:97], 0
  v_mfma_f32_16x16x16_bf16 v[16:19], v[86:87], v[96:97], 0
  v_mfma_f32_16x16x16_bf16 v[8:11], v[78:79], v[66:67], 0
  v_max_u32 v71, v71, v24
  s_cbranch_scc1 LB_e1_f
  v_mul_u32_u24 v24, 0x12d, v24
  v_lshlrev_b32 v25, 22, v24
  v_sub_u32 v20, v20, v25
  v_sub_u32 v21, v21, v25
  v_ashrrev_i32 v26, 22, v20
  v_add_u32 v26, v26, v24
  v_ashrrev_i32 v26, 10, v26
  v_sub_u32 v21, v21, v26
  v_sub_u32 v22, v22, v25
  v_sub_u32 v23, v23, v25
  v_ashrrev_i32 v26, 22, v22
  v_add_u32 v26, v26, v24
  v_ashrrev_i32 v26, 10, v26
  v_sub_u32 v23, v23, v26
  v_cvt_f32_i32 v20, v20
  v_cvt_f32_i32 v21, v21
  v_cvt_f32_i32 v22, v22
  v_cvt_f32_i32 v23, v23
LB_e1_f:
  v_cvt_pk_bf16_f32 v68, v20, v21
  v_cvt_pk_bf16_f32 v69, v22, v23
  v_mfma_f32_16x16x16_bf16 v[24:27], v[84:85], v[98:99], 0
  v_mfma_f32_16x16x16_bf16 v[28:31], v[86:87], v[98:99], 0
  v_mfma_f32_16x16x16_bf16 v[20:23], v[78:79], v[68:69], 0
  v_max_u32 v71, v71, v36
  s_cbranch_scc1 LB_e2_f
  v_mul_u32_u24 v36, 0x12d, v36
  v_lshlrev_b32 v37, 22, v36
  v_sub_u32 v32, v32, v37
  v_sub_u32 v33, v33, v37
  v_ashrrev_i32 v38, 22, v32
  v_add_u32 v38, v38, v36
  v_ashrrev_i32 v38, 10, v38
  v_sub_u32 v33, v33, v38
  v_sub_u32 v34, v34, v37
  v_sub_u32 v35, v35, v37
  v_ashrrev_i32 v38, 22, v34
  v_add_u32 v38, v38, v36
  v_ashrrev_i32 v38, 10, v38
  v_sub_u32 v35, v35, v38
  v_cvt_f32_i32 v32, v32
  v_cvt_f32_i32 v33, v33
  v_cvt_f32_i32 v34, v34
  v_cvt_f32_i32 v35, v35
LB_e2_f:
  v_cvt_pk_bf16_f32 v66, v32, v33
  v_cvt_pk_bf16_f32 v67, v34, v35
  v_mfma_f32_16x16x16_bf16 v[36:39], v[84:85], v[100:101], 0
  v_mfma_f32_16x16x16_bf16 v[40:43], v[86:87], v[100:101], 0
  v_mfma_f32_16x16x16_bf16 v[32:35], v[78:79], v[66:67], 0
  v_max_u32 v71, v71, v48
  s_cbranch_scc1 LB_e3_f
  v_mul_u32_u24 v48, 0x12d, v48
  v_lshlrev_b32 v49, 22, v48
  v_sub_u32 v44, v44, v49
  v_sub_u32 v45, v45, v49
  v_ashrrev_i32 v50, 22, v44
  v_add_u32 v50, v50, v48
  v_ashrrev_i32 v50, 10, v50
  v_sub_u32 v45, v45, v50
  v_sub_u32 v46, v46, v49
  v_sub_u32 v47, v47, v49
  v_ashrrev_i32 v50, 22, v46
  v_add_u32 v50, v50, v48
  v_ashrrev_i32 v50, 10, v50
  v_sub_u32 v47, v47, v50
  v_cvt_f32_i32 v44, v44
  v_cvt_f32_i32 v45, v45
  v_cvt_f32_i32 v46, v46
  v_cvt_f32_i32 v47, v47
LB_e3_f:
  v_cvt_pk_bf16_f32 v68, v44, v45
  v_cvt_pk_bf16_f32 v69, v46, v47
  v_mfma_f32_16x16x16_bf16 v[48:51], v[84:85], v[102:103], 0
  v_mfma_f32_16x16x16_bf16 v[52:55], v[86:87], v[102:103], 0
  v_mfma_f32_16x16x16_bf16 v[44:47], v[78:79], v[68:69], 0
  s_nop 7
  v_mul_f32 v8, v8, v12
  v_mul_f32 v9, v9, v13
  v_mul_f32 v10, v10, v14
  v_mul_f32 v11, v11, v15
  v_cvt_pk_bf16_f32 v66, v8, v9
  v_cvt_pk_bf16_f32 v67, v10, v11
  s_nop 1
  v_mfma_f32_16x16x16_bf16 v[12:15], v[82:83], v[66:67], 0
  v_mul_f32 v20, v20, v24
  v_mul_f32 v21, v21, v25
  v_mul_f32 v22, v22, v26
  v_mul_f32 v23, v23, v27
  v_cvt_pk_bf16_f32 v68, v20, v21
  v_cvt_pk_bf16_f32 v69, v22, v23
  s_nop 1
  v_mfma_f32_16x16x16_bf16 v[24:27], v[82:83], v[68:69], 0
  v_mul_f32 v32, v32, v36
  v_mul_f32 v33, v33, v37
  v_mul_f32 v34, v34, v38
  v_mul_f32 v35, v35, v39
  v_cvt_pk_bf16_f32 v66, v32, v33
  v_cvt_pk_bf16_f32 v67, v34, v35
  s_nop 1
  v_mfma_f32_16x16x16_bf16 v[36:39], v[82:83], v[66:67], 0
  v_mul_f32 v44, v44, v48
  v_mul_f32 v45, v45, v49
  v_mul_f32 v46, v46, v50
  v_mul_f32 v47, v47, v51
  v_cvt_pk_bf16_f32 v68, v44, v45
  v_cvt_pk_bf16_f32 v69, v46, v47
  s_nop 1
  v_mfma_f32_16x16x16_bf16 v[48:51], v[82:83], v[68:69], 0
  s_waitcnt vmcnt(0)
  s_nop 7
  v_lshlrev_b32 v8, 16, v110
  v_and_b32 v9, 0xffff0000, v110
  v_lshlrev_b32 v10, 16, v111
  v_and_b32 v11, 0xffff0000, v111
  v_fmac_f32 v8, v12, v16
  v_fmac_f32 v9, v13, v17
  v_fmac_f32 v10, v14, v18
  v_fmac_f32 v11, v15, v19
  v_cvt_pk_bf16_f32 v110, v8, v9
  v_cvt_pk_bf16_f32 v111, v10, v11
  s_mov_b32 s81, 0
  buffer_store_dwordx2 v[110:111], v62, s[28:31], s81 offen nt
  v_lshlrev_b32 v20, 16, v112
  v_and_b32 v21, 0xffff0000, v112
  v_lshlrev_b32 v22, 16, v113
  v_and_b32 v23, 0xffff0000, v113
  v_fmac_f32 v20, v24, v28
  v_fmac_f32 v21, v25, v29
  v_fmac_f32 v22, v26, v30
  v_fmac_f32 v23, v27, v31
  v_cvt_pk_bf16_f32 v112, v20, v21
  v_cvt_pk_bf16_f32 v113, v22, v23
  s_mov_b32 s81, 8192
  buffer_store_dwordx2 v[112:113], v62, s[28:31], s81 offen nt
  v_lshlrev_b32 v32, 16, v114
  v_and_b32 v33, 0xffff0000, v114
  v_lshlrev_b32 v34, 16, v115
  v_and_b32 v35, 0xffff0000, v115
  v_fmac_f32 v32, v36, v40
  v_fmac_f32 v33, v37, v41
  v_fmac_f32 v34, v38, v42
  v_fmac_f32 v35, v39, v43
  v_cvt_pk_bf16_f32 v114, v32, v33
  v_cvt_pk_bf16_f32 v115, v34, v35
  s_mov_b32 s81, 16384
  buffer_store_dwordx2 v[114:115], v62, s[28:31], s81 offen nt
  v_lshlrev_b32 v44, 16, v116
  v_and_b32 v45, 0xffff0000, v116
  v_lshlrev_b32 v46, 16, v117
  v_and_b32 v47, 0xffff0000, v117
  v_fmac_f32 v44, v48, v52
  v_fmac_f32 v45, v49, v53
  v_fmac_f32 v46, v50, v54
  v_fmac_f32 v47, v51, v55
  v_cvt_pk_bf16_f32 v116, v44, v45
  v_cvt_pk_bf16_f32 v117, v46, v47
  s_mov_b32 s81, 24576
  buffer_store_dwordx2 v[116:117], v62, s[28:31], s81 offen nt
  ds_read_b128 v[8:11], v60 offset:0
  ds_read_b32 v12, v59 offset:64
  ds_read_b128 v[20:23], v60 offset:20480
  ds_read_b32 v24, v59 offset:20544
  s_cmp_ge_u32 s50, 2
  s_cbranch_scc1 LB_skip6a
  ds_read_b128 v[32:35], v60 offset:40960
  ds_read_b32 v36, v59 offset:41024
LB_skip6a:
  s_waitcnt lgkmcnt(0)
  s_cmp_eq_u32 s56, 2
  v_max_u32 v71, v71, v12
  s_cbranch_scc1 LB_e4_f
  v_mul_u32_u24 v12, 0x12d, v12
  v_lshlrev_b32 v13, 22, v12
  v_sub_u32 v8, v8, v13
  v_sub_u32 v9, v9, v13
  v_ashrrev_i32 v14, 22, v8
  v_add_u32 v14, v14, v12
  v_ashrrev_i32 v14, 10, v14
  v_sub_u32 v9, v9, v14
  v_sub_u32 v10, v10, v13
  v_sub_u32 v11, v11, v13
  v_ashrrev_i32 v14, 22, v10
  v_add_u32 v14, v14, v12
  v_ashrrev_i32 v14, 10, v14
  v_sub_u32 v11, v11, v14
  v_cvt_f32_i32 v8, v8
  v_cvt_f32_i32 v9, v9
  v_cvt_f32_i32 v10, v10
  v_cvt_f32_i32 v11, v11
LB_e4_f:
  v_cvt_pk_bf16_f32 v66, v8, v9
  v_cvt_pk_bf16_f32 v67, v10, v11
  v_mfma_f32_16x16x16_bf16 v[12:15], v[84:85], v[104:105], 0
  v_mfma_f32_16x16x16_bf16 v[16:19], v[86:87], v[104:105], 0
  v_mfma_f32_16x16x16_bf16 v[8:11], v[78:79], v[66:67], 0
  v_max_u32 v71, v71, v24
  s_cbranch_scc1 LB_e5_f
  v_mul_u32_u24 v24, 0x12d, v24
  v_lshlrev_b32 v25, 22, v24
  v_sub_u32 v20, v20, v25
  v_sub_u32 v21, v21, v25
  v_ashrrev_i32 v26, 22, v20
  v_add_u32 v26, v26, v24
  v_ashrrev_i32 v26, 10, v26
  v_sub_u32 v21, v21, v26
  v_sub_u32 v22, v22, v25
  v_sub_u32 v23, v23, v25
  v_ashrrev_i32 v26, 22, v22
  v_add_u32 v26, v26, v24
  v_ashrrev_i32 v26, 10, v26
  v_sub_u32 v23, v23, v26
  v_cvt_f32_i32 v20, v20
  v_cvt_f32_i32 v21, v21
  v_cvt_f32_i32 v22, v22
  v_cvt_f32_i32 v23, v23
LB_e5_f:
  v_cvt_pk_bf16_f32 v68, v20, v21
  v_cvt_pk_bf16_f32 v69, v22, v23
  v_mfma_f32_16x16x16_bf16 v[24:27], v[84:85], v[106:107], 0
  v_mfma_f32_16x16x16_bf16 v[28:31], v[86:87], v[106:107], 0
  v_mfma_f32_16x16x16_bf16 v[20:23], v[78:79], v[68:69], 0
  s_cmp_ge_u32 s50, 2
  s_cbranch_scc1 LB_skip6b
  s_cmp_eq_u32 s56, 2
  v_max_u32 v71, v71, v36
  s_cbranch_scc1 LB_e6_f
  v_mul_u32_u24 v36, 0x12d, v36
  v_lshlrev_b32 v37, 22, v36
  v_sub_u32 v32, v32, v37
  v_sub_u32 v33, v33, v37
  v_ashrrev_i32 v38, 22, v32
  v_add_u32 v38, v38, v36
  v_ashrrev_i32 v38, 10, v38
  v_sub_u32 v33, v33, v38
  v_sub_u32 v34, v34, v37
  v_sub_u32 v35, v35, v37
  v_ashrrev_i32 v38, 22, v34
  v_add_u32 v38, v38, v36
  v_ashrrev_i32 v38, 10, v38
  v_sub_u32 v35, v35, v38
  v_cvt_f32_i32 v32, v32
  v_cvt_f32_i32 v33, v33
  v_cvt_f32_i32 v34, v34
  v_cvt_f32_i32 v35, v35
LB_e6_f:
  v_cvt_pk_bf16_f32 v66, v32, v33
  v_cvt_pk_bf16_f32 v67, v34, v35
  v_mfma_f32_16x16x16_bf16 v[36:39], v[84:85], v[108:109], 0
  v_mfma_f32_16x16x16_bf16 v[40:43], v[86:87], v[108:109], 0
  v_mfma_f32_16x16x16_bf16 v[32:35], v[78:79], v[66:67], 0
LB_skip6b:
  s_nop 7
  v_mul_f32 v8, v8, v12
  v_mul_f32 v9, v9, v13
  v_mul_f32 v10, v10, v14
  v_mul_f32 v11, v11, v15
  v_cvt_pk_bf16_f32 v66, v8, v9
  v_cvt_pk_bf16_f32 v67, v10, v11
  s_nop 1
  v_mfma_f32_16x16x16_bf16 v[12:15], v[82:83], v[66:67], 0
  v_mul_f32 v20, v20, v24
  v_mul_f32 v21, v21, v25
  v_mul_f32 v22, v22, v26
  v_mul_f32 v23, v23, v27
  v_cvt_pk_bf16_f32 v68, v20, v21
  v_cvt_pk_bf16_f32 v69, v22, v23
  s_nop 1
  v_mfma_f32_16x16x16_bf16 v[24:27], v[82:83], v[68:69], 0
  s_cmp_ge_u32 s50, 2
  s_cbranch_scc1 LB_skip6c
  v_mul_f32 v32, v32, v36
  v_mul_f32 v33, v33, v37
  v_mul_f32 v34, v34, v38
  v_mul_f32 v35, v35, v39
  v_cvt_pk_bf16_f32 v66, v32, v33
  v_cvt_pk_bf16_f32 v67, v34, v35
  s_nop 1
  v_mfma_f32_16x16x16_bf16 v[36:39], v[82:83], v[66:67], 0
LB_skip6c:
  s_nop 7
  v_lshlrev_b32 v8, 16, v118
  v_and_b32 v9, 0xffff0000, v118
  v_lshlrev_b32 v10, 16, v119
  v_and_b32 v11, 0xffff0000, v119
  v_fmac_f32 v8, v12, v16
  v_fmac_f32 v9, v13, v17
  v_fmac_f32 v10, v14, v18
  v_fmac_f32 v11, v15, v19
  v_cvt_pk_bf16_f32 v118, v8, v9
  v_cvt_pk_bf16_f32 v119, v10, v11
  s_mov_b32 s81, 32768
  buffer_store_dwordx2 v[118:119], v62, s[28:31], s81 offen nt
  v_lshlrev_b32 v20, 16, v120
  v_and_b32 v21, 0xffff0000, v120
  v_lshlrev_b32 v22, 16, v121
  v_and_b32 v23, 0xffff0000, v121
  v_fmac_f32 v20, v24, v28
  v_fmac_f32 v21, v25, v29
  v_fmac_f32 v22, v26, v30
  v_fmac_f32 v23, v27, v31
  v_cvt_pk_bf16_f32 v120, v20, v21
  v_cvt_pk_bf16_f32 v121, v22, v23
  s_mov_b32 s81, 40960
  buffer_store_dwordx2 v[120:121], v62, s[28:31], s81 offen nt
  s_cmp_ge_u32 s50, 2
  s_cbranch_scc1 LB_skip6d
  v_lshlrev_b32 v32, 16, v122
  v_and_b32 v33, 0xffff0000, v122
  v_lshlrev_b32 v34, 16, v123
  v_and_b32 v35, 0xffff0000, v123
  v_fmac_f32 v32, v36, v40
  v_fmac_f32 v33, v37, v41
  v_fmac_f32 v34, v38, v42
  v_fmac_f32 v35, v39, v43
  v_cvt_pk_bf16_f32 v122, v32, v33
  v_cvt_pk_bf16_f32 v123, v34, v35
  s_mov_b32 s81, 49152
  buffer_store_dwordx2 v[122:123], v62, s[28:31], s81 offen nt
LB_skip6d:
  v_cmp_lt_u32 vcc, 0x1ff, v71
  s_mov_b64 s[66:67], vcc
  s_cmp_eq_u32 s56, 2
  s_cbranch_scc1 LB_end
  s_cmp_eq_u64 s[66:67], 0
  s_cbranch_scc1 LB_noov
  v_mov_b32 v59, 130048
  ds_write_b32 v59, v7
LB_noov:
  s_waitcnt lgkmcnt(0)
  s_barrier
  v_mov_b32 v59, 130048
  ds_read_b32 v59, v59
  s_waitcnt lgkmcnt(0)
  v_readfirstlane_b32 s80, v59
  s_cmp_eq_u32 s80, 0
  s_cbranch_scc1 LB_end
  s_waitcnt vmcnt(0)
  s_barrier
  s_mov_b32 s56, 2
  s_branch LB_start
LB_end:
  s_endpgm
.section .rodata,"a"
.p2align 6
.amdhsa_kernel standalone__molecular_angular_gemnet__graph_part_kernel
  .amdhsa_next_free_vgpr 128
  .amdhsa_next_free_sgpr 102
  .amdhsa_accum_offset 128
  .amdhsa_group_segment_fixed_size 0
  .amdhsa_kernarg_size 112
  .amdhsa_user_sgpr_count 2
  .amdhsa_user_sgpr_kernarg_segment_ptr 1
  .amdhsa_system_sgpr_workgroup_id_x 1
  .amdhsa_float_denorm_mode_32 3
.end_amdhsa_kernel
.p2align 6
.amdhsa_kernel standalone__molecular_angular_gemnet__graph_kernel
  .amdhsa_next_free_vgpr 128
  .amdhsa_next_free_sgpr 102
  .amdhsa_accum_offset 128
  .amdhsa_group_segment_fixed_size 0
  .amdhsa_kernarg_size 112
  .amdhsa_user_sgpr_count 2
  .amdhsa_user_sgpr_kernarg_segment_ptr 1
  .amdhsa_system_sgpr_workgroup_id_x 1
  .amdhsa_float_denorm_mode_32 3
.end_amdhsa_kernel
```
